```python
import torch

def _softmax(x, axis=-1):
    return torch.softmax(x, dim=axis)
def _gelu(x):
    return torch.nn.functional.gelu(x, approximate="tanh")
def _silu(x):
    return torch.nn.functional.silu(x)
def _sigmoid(x):
    return torch.sigmoid(x)
def _layernorm(x, axis=-1, eps=1e-5):
    m = x.mean(dim=axis, keepdim=True)
    v = x.var(dim=axis, keepdim=True, unbiased=False)
    return (x - m) / torch.sqrt(v + eps)
def _scatter_add(tgt, idx, src, axis=0):
    return tgt.clone().index_add_(axis, idx, src)
def _segment_sum(src, seg, n):
    out = torch.zeros((n,) + src.shape[1:], dtype=src.dtype)
    return out.index_add_(0, seg, src)
def _pad(x, pw):
    flat = tuple(v for pair in reversed(pw) for v in pair)
    return torch.nn.functional.pad(x, flat)

kernel_name = 'interleave_layers__mha_block__dense_activation_relu__prompt'

def setup_inputs():

    _w = (lambda a: (lambda t: t.to(torch.bfloat16) if t.is_floating_point() else t)(torch.as_tensor(a)))
    def _A_setup():
        B, S, D, H = 1, 2048, 512, 32
        return {
            "x": _w((lambda *s: torch.randn(*s, dtype=torch.bfloat16) * 0.05)(B, S, D)),
            "wqkv": _w((lambda *s: torch.randn(*s, dtype=torch.bfloat16) * 0.05)(D, 3 * D)),
            "wo": _w((lambda *s: torch.randn(*s, dtype=torch.bfloat16) * 0.05)(D, D)),
        }
    _A_in = _A_setup()

    def _B_setup():
        B, S, D, Dff = 1, 2048, 512, 1792
        return {
            "x": _w((lambda *s: torch.randn(*s, dtype=torch.bfloat16) * 0.05)(B, S, D)),
            "w1": _w((lambda *s: torch.randn(*s, dtype=torch.bfloat16) * 0.05)(D, Dff)),
            "w2": _w((lambda *s: torch.randn(*s, dtype=torch.bfloat16) * 0.05)(Dff, D)),
        }
    _B_in = _B_setup()

    return {
        "A_x": _A_in["x"],
        "A_wqkv": _A_in["wqkv"],
        "A_wo": _A_in["wo"],
        "B_x": _B_in["x"],
        "B_w1": _B_in["w1"],
        "B_w2": _B_in["w2"],
    }

def reference(A_x, A_wqkv, A_wo, B_x, B_w1, B_w2):
    def _A_ref(x, wqkv, wo):
        B, S, D = x.shape
        H = 32
        Dh = D // H
        qkv = (lambda x, *d: x.permute(*d))((x @ wqkv).reshape(B, S, 3, H, Dh), 2, 0, 3, 1, 4)
        q, k, v = qkv[0], qkv[1], qkv[2]
        scores = torch.einsum("bhqd,bhkd->bhqk", q, k) * (Dh ** -0.5)
        p = _softmax(scores, axis=-1)
        o = torch.einsum("bhqk,bhkd->bhqd", p, v)
        return (lambda x, *d: x.permute(*d))(o, 0, 2, 1, 3).reshape(B, S, D) @ wo

    def _B_ref(x, w1, w2):
        h = torch.einsum("bsd,df->bsf", x, w1)
        zero = torch.zeros_like(h)
        h = torch.maximum(h, zero)
        return torch.einsum("bsf,fd->bsd", h, w2)

    x = A_x
    x = x + _A_ref(_layernorm(x, axis=-1), A_wqkv, A_wo)
    x = x + _B_ref(_layernorm(x, axis=-1), B_w1, B_w2)
    x = x + _A_ref(_layernorm(x, axis=-1), A_wqkv, A_wo)
    x = x + _B_ref(_layernorm(x, axis=-1), B_w1, B_w2)
    return x
```

```asm
; @launch kernel=prep_kernel grid=(240,1,1) block=(256,1,1) lds=33280
; @launch kernel=main_kernel grid=(256,1,1) block=(512,1,1) lds=163840
.amdgcn_target "amdgcn-amd-amdhsa--gfx950"
.text
.globl prep_kernel
.p2align 8
.type prep_kernel,@function
prep_kernel:
  s_cmp_ge_u32 s2, 240
  s_cbranch_scc1 prep_end
  s_load_dwordx2 s[16:17], s[0:1], 64
  s_load_dwordx4 s[20:23], s[0:1], 0
  s_load_dwordx2 s[24:25], s[0:1], 16
  s_load_dwordx4 s[28:31], s[0:1], 32
  v_lshrrev_b32 v1, 6, v0
  s_nop 0
  v_readfirstlane_b32 s3, v1
  v_and_b32 v1, 63, v0
  v_and_b32 v3, 31, v1
  v_lshrrev_b32 v4, 5, v1
  v_lshlrev_b32 v5, 4, v1
  s_waitcnt lgkmcnt(0)
  s_mov_b32 s4, s16
  s_and_b32 s5, s17, 0xffff
  s_mov_b32 s6, 0x10000000
  s_mov_b32 s7, 0x20000
  s_cmp_eq_u32 s3, 3
  s_cbranch_scc0 prep_nocode
  s_getpc_b64 s[44:45]
prep_pc:
  s_add_u32 s44, s44, main_kernel-prep_pc
  s_addc_u32 s45, s45, 0
  v_lshlrev_b32 v60, 7, v1
  v_min_u32 v61, main_end-main_kernel, v60
  global_load_dword v62, v61, s[44:45]
  v_add_u32 v60, 0x2000, v60
  v_min_u32 v61, main_end-main_kernel, v60
  global_load_dword v62, v61, s[44:45]
  v_add_u32 v60, 0x2000, v60
  v_min_u32 v61, main_end-main_kernel, v60
  global_load_dword v62, v61, s[44:45]
  v_add_u32 v60, 0x2000, v60
  v_min_u32 v61, main_end-main_kernel, v60
  global_load_dword v62, v61, s[44:45]
  v_add_u32 v60, 0x2000, v60
prep_nocode:
  s_cmp_eq_u32 s2, 0
  s_cbranch_scc0 prep_nz
  v_lshlrev_b32 v8, 4, v0
  v_mov_b32 v12, 0
  v_mov_b32 v13, 0
  v_mov_b32 v14, 0
  v_mov_b32 v15, 0
  s_mov_b32 s33, 0x2200000
  buffer_store_dwordx4 v[12:15], v8, s[4:7], s33 offen
prep_nz:
  s_lshl_b32 s35, s3, 3
  s_mov_b32 s37, 0
  s_cmp_lt_u32 s2, 48
  s_cbranch_scc1 prep_wqkv
  s_cmp_lt_u32 s2, 104
  s_cbranch_scc1 prep_w1
  s_cmp_lt_u32 s2, 120
  s_cbranch_scc1 prep_wo
  s_cmp_lt_u32 s2, 176
  s_cbranch_scc1 prep_w2
  s_branch prep_x
prep_wqkv:
  s_mov_b32 s8, s22
  s_and_b32 s9, s23, 0xffff
  s_mov_b32 s10, 0x180000
  s_mov_b32 s11, 0x20000
  s_mov_b32 s33, 3072
  s_mov_b32 s34, s2
  s_lshl_b32 s36, s34, 5
  s_add_u32 s36, s36, s35
  s_lshl_b32 s36, s36, 10
  s_add_u32 s36, s36, 0x1800000
  s_lshl_b32 s37, s34, 7
  s_add_u32 s37, s37, 0x1f00000
  s_branch prep_w
prep_w1:
  s_mov_b32 s8, s28
  s_and_b32 s9, s29, 0xffff
  s_mov_b32 s10, 0x1c0000
  s_mov_b32 s11, 0x20000
  s_mov_b32 s33, 3584
  s_sub_u32 s34, s2, 48
  s_lshl_b32 s36, s34, 5
  s_add_u32 s36, s36, s35
  s_lshl_b32 s36, s36, 10
  s_add_u32 s36, s36, 0x1b00000
  s_lshl_b32 s37, s34, 7
  s_add_u32 s37, s37, 0x1f02000
  s_branch prep_w
prep_wo:
  s_mov_b32 s8, s24
  s_and_b32 s9, s25, 0xffff
  s_mov_b32 s10, 0x80000
  s_mov_b32 s11, 0x20000
  s_mov_b32 s33, 1024
  s_sub_u32 s34, s2, 104
  s_lshl_b32 s36, s34, 5
  s_add_u32 s36, s36, s35
  s_lshl_b32 s36, s36, 10
  s_add_u32 s36, s36, 0x1a00000
  s_branch prep_w
prep_w2:
  s_mov_b32 s8, s30
  s_and_b32 s9, s31, 0xffff
  s_mov_b32 s10, 0x1c0000
  s_mov_b32 s11, 0x20000
  s_mov_b32 s33, 1024
  s_sub_u32 s38, s2, 120
  s_lshl_b32 s38, s38, 2
  s_add_u32 s38, s38, s3
  s_mul_i32 s34, s38, 4682
  s_lshr_b32 s34, s34, 16
  s_mul_i32 s39, s34, 14
  s_sub_u32 s35, s38, s39
  s_lshl_b32 s35, s35, 3
  s_mul_i32 s36, s34, 112
  s_add_u32 s36, s36, s35
  s_lshl_b32 s36, s36, 10
  s_add_u32 s36, s36, 0x1d00000
prep_w:
  v_lshrrev_b32 v6, 2, v1
  v_mul_lo_u32 v6, v6, s33
  v_and_b32 v8, 3, v1
  v_lshl_add_u32 v8, v8, 4, v6
  s_mul_i32 s40, s35, s33
  s_lshl_b32 s40, s40, 4
  s_lshl_b32 s41, s34, 6
  s_add_u32 s40, s40, s41
  s_lshl_b32 s41, s33, 4
  s_lshl_b32 s43, s3, 13
  s_add_u32 m0, s43, 0
  s_nop 0
  buffer_load_dwordx4 v8, s[8:11], s40 offen lds
  s_add_u32 s40, s40, s41
  s_add_u32 m0, s43, 1024
  s_nop 0
  buffer_load_dwordx4 v8, s[8:11], s40 offen lds
  s_add_u32 s40, s40, s41
  s_add_u32 m0, s43, 2048
  s_nop 0
  buffer_load_dwordx4 v8, s[8:11], s40 offen lds
  s_add_u32 s40, s40, s41
  s_add_u32 m0, s43, 3072
  s_nop 0
  buffer_load_dwordx4 v8, s[8:11], s40 offen lds
  s_add_u32 s40, s40, s41
  s_add_u32 m0, s43, 4096
  s_nop 0
  buffer_load_dwordx4 v8, s[8:11], s40 offen lds
  s_add_u32 s40, s40, s41
  s_add_u32 m0, s43, 5120
  s_nop 0
  buffer_load_dwordx4 v8, s[8:11], s40 offen lds
  s_add_u32 s40, s40, s41
  s_add_u32 m0, s43, 6144
  s_nop 0
  buffer_load_dwordx4 v8, s[8:11], s40 offen lds
  s_add_u32 s40, s40, s41
  s_add_u32 m0, s43, 7168
  s_nop 0
  buffer_load_dwordx4 v8, s[8:11], s40 offen lds
  s_add_u32 s40, s40, s41
  v_lshrrev_b32 v9, 5, v1
  v_lshlrev_b32 v9, 2, v9
  v_bfe_u32 v10, v1, 2, 2
  v_add_u32 v9, v9, v10
  v_lshlrev_b32 v9, 6, v9
  v_bfe_u32 v10, v1, 4, 1
  v_lshl_add_u32 v9, v10, 5, v9
  v_and_b32 v10, 3, v1
  v_lshl_add_u32 v9, v10, 3, v9
  v_add_u32 v9, s43, v9
  v_mov_b32 v12, 0
  v_mov_b32 v13, 0x3f803f80
  s_waitcnt vmcnt(7)
  ds_read_b64_tr_b16 v[16:17], v9 offset:0
  ds_read_b64_tr_b16 v[18:19], v9 offset:512
  s_waitcnt vmcnt(6)
  ds_read_b64_tr_b16 v[20:21], v9 offset:1024
  ds_read_b64_tr_b16 v[22:23], v9 offset:1536
  s_waitcnt vmcnt(5)
  ds_read_b64_tr_b16 v[24:25], v9 offset:2048
  ds_read_b64_tr_b16 v[26:27], v9 offset:2560
  s_waitcnt vmcnt(4)
  ds_read_b64_tr_b16 v[28:29], v9 offset:3072
  ds_read_b64_tr_b16 v[30:31], v9 offset:3584
  s_waitcnt vmcnt(3)
  ds_read_b64_tr_b16 v[32:33], v9 offset:4096
  ds_read_b64_tr_b16 v[34:35], v9 offset:4608
  s_waitcnt vmcnt(2)
  ds_read_b64_tr_b16 v[36:37], v9 offset:5120
  ds_read_b64_tr_b16 v[38:39], v9 offset:5632
  s_waitcnt vmcnt(1)
  ds_read_b64_tr_b16 v[40:41], v9 offset:6144
  ds_read_b64_tr_b16 v[42:43], v9 offset:6656
  s_waitcnt vmcnt(0)
  ds_read_b64_tr_b16 v[44:45], v9 offset:7168
  ds_read_b64_tr_b16 v[46:47], v9 offset:7680
  s_waitcnt lgkmcnt(0)
  v_dot2c_f32_bf16 v12, v16, v13
  v_dot2c_f32_bf16 v12, v17, v13
  v_dot2c_f32_bf16 v12, v18, v13
  v_dot2c_f32_bf16 v12, v19, v13
  v_dot2c_f32_bf16 v12, v20, v13
  v_dot2c_f32_bf16 v12, v21, v13
  v_dot2c_f32_bf16 v12, v22, v13
  v_dot2c_f32_bf16 v12, v23, v13
  v_dot2c_f32_bf16 v12, v24, v13
  v_dot2c_f32_bf16 v12, v25, v13
  v_dot2c_f32_bf16 v12, v26, v13
  v_dot2c_f32_bf16 v12, v27, v13
  v_dot2c_f32_bf16 v12, v28, v13
  v_dot2c_f32_bf16 v12, v29, v13
  v_dot2c_f32_bf16 v12, v30, v13
  v_dot2c_f32_bf16 v12, v31, v13
  v_dot2c_f32_bf16 v12, v32, v13
  v_dot2c_f32_bf16 v12, v33, v13
  v_dot2c_f32_bf16 v12, v34, v13
  v_dot2c_f32_bf16 v12, v35, v13
  v_dot2c_f32_bf16 v12, v36, v13
  v_dot2c_f32_bf16 v12, v37, v13
  v_dot2c_f32_bf16 v12, v38, v13
  v_dot2c_f32_bf16 v12, v39, v13
  v_dot2c_f32_bf16 v12, v40, v13
  v_dot2c_f32_bf16 v12, v41, v13
  v_dot2c_f32_bf16 v12, v42, v13
  v_dot2c_f32_bf16 v12, v43, v13
  v_dot2c_f32_bf16 v12, v44, v13
  v_dot2c_f32_bf16 v12, v45, v13
  v_dot2c_f32_bf16 v12, v46, v13
  v_dot2c_f32_bf16 v12, v47, v13
  s_add_u32 s42, s36, 4096
  buffer_store_dwordx4 v[16:19], v5, s[4:7], s36 offen offset:0
  buffer_store_dwordx4 v[20:23], v5, s[4:7], s36 offen offset:1024
  buffer_store_dwordx4 v[24:27], v5, s[4:7], s36 offen offset:2048
  buffer_store_dwordx4 v[28:31], v5, s[4:7], s36 offen offset:3072
  buffer_store_dwordx4 v[32:35], v5, s[4:7], s42 offen offset:0
  buffer_store_dwordx4 v[36:39], v5, s[4:7], s42 offen offset:1024
  buffer_store_dwordx4 v[40:43], v5, s[4:7], s42 offen offset:2048
  buffer_store_dwordx4 v[44:47], v5, s[4:7], s42 offen offset:3072
  s_cmp_eq_u32 s37, 0
  s_cbranch_scc1 prep_end
  s_nop 4
  v_mov_b32 v14, v12
  s_nop 1
  v_permlane32_swap_b32 v12, v14
  s_nop 1
  v_add_f32 v12, v12, v14
  v_lshlrev_b32 v15, 2, v3
  s_lshl_b32 s43, s3, 7
  v_add_u32 v15, 0x8000, v15
  v_add_u32 v14, s43, v15
  ds_write_b32 v14, v12
  s_waitcnt lgkmcnt(0)
  s_barrier
  s_cmp_lg_u32 s3, 0
  s_cbranch_scc1 prep_end
  ds_read_b32 v16, v15
  ds_read_b32 v17, v15 offset:128
  ds_read_b32 v18, v15 offset:256
  ds_read_b32 v19, v15 offset:384
  s_waitcnt lgkmcnt(0)
  v_add_f32 v16, v16, v17
  v_add_f32 v18, v18, v19
  v_add_f32 v16, v16, v18
  v_lshlrev_b32 v15, 2, v3
  buffer_store_dword v16, v15, s[4:7], s37 offen
  s_branch prep_end
prep_x:
  s_mov_b32 s8, s20
  s_and_b32 s9, s21, 0xffff
  s_mov_b32 s10, 0x200000
  s_mov_b32 s11, 0x20000
  s_sub_u32 s34, s2, 176
  v_lshlrev_b32 v8, 10, v3
  v_lshl_add_u32 v8, v4, 3, v8
  s_lshl_b32 s40, s34, 15
  s_lshl_b32 s41, s35, 5
  s_add_u32 s40, s40, s41
  buffer_load_dwordx2 v[16:17], v8, s[8:11], s40 offen offset:0
  buffer_load_dwordx2 v[18:19], v8, s[8:11], s40 offen offset:16
  buffer_load_dwordx2 v[20:21], v8, s[8:11], s40 offen offset:32
  buffer_load_dwordx2 v[22:23], v8, s[8:11], s40 offen offset:48
  buffer_load_dwordx2 v[24:25], v8, s[8:11], s40 offen offset:64
  buffer_load_dwordx2 v[26:27], v8, s[8:11], s40 offen offset:80
  buffer_load_dwordx2 v[28:29], v8, s[8:11], s40 offen offset:96
  buffer_load_dwordx2 v[30:31], v8, s[8:11], s40 offen offset:112
  buffer_load_dwordx2 v[32:33], v8, s[8:11], s40 offen offset:128
  buffer_load_dwordx2 v[34:35], v8, s[8:11], s40 offen offset:144
  buffer_load_dwordx2 v[36:37], v8, s[8:11], s40 offen offset:160
  buffer_load_dwordx2 v[38:39], v8, s[8:11], s40 offen offset:176
  buffer_load_dwordx2 v[40:41], v8, s[8:11], s40 offen offset:192
  buffer_load_dwordx2 v[42:43], v8, s[8:11], s40 offen offset:208
  buffer_load_dwordx2 v[44:45], v8, s[8:11], s40 offen offset:224
  buffer_load_dwordx2 v[46:47], v8, s[8:11], s40 offen offset:240
  v_mov_b32 v12, 0
  v_mov_b32 v13, 0
  v_mov_b32 v14, 0x3f803f80
  s_lshl_b32 s36, s34, 5
  s_add_u32 s36, s36, s35
  s_lshl_b32 s36, s36, 10
  s_add_u32 s42, s36, 4096
  s_waitcnt vmcnt(0)
  buffer_store_dwordx4 v[16:19], v5, s[4:7], s36 offen offset:0
  buffer_store_dwordx4 v[20:23], v5, s[4:7], s36 offen offset:1024
  buffer_store_dwordx4 v[24:27], v5, s[4:7], s36 offen offset:2048
  buffer_store_dwordx4 v[28:31], v5, s[4:7], s36 offen offset:3072
  buffer_store_dwordx4 v[32:35], v5, s[4:7], s42 offen offset:0
  buffer_store_dwordx4 v[36:39], v5, s[4:7], s42 offen offset:1024
  buffer_store_dwordx4 v[40:43], v5, s[4:7], s42 offen offset:2048
  buffer_store_dwordx4 v[44:47], v5, s[4:7], s42 offen offset:3072
  v_dot2c_f32_bf16 v12, v16, v14
  v_dot2c_f32_bf16 v13, v16, v16
  v_dot2c_f32_bf16 v12, v17, v14
  v_dot2c_f32_bf16 v13, v17, v17
  v_dot2c_f32_bf16 v12, v18, v14
  v_dot2c_f32_bf16 v13, v18, v18
  v_dot2c_f32_bf16 v12, v19, v14
  v_dot2c_f32_bf16 v13, v19, v19
  v_dot2c_f32_bf16 v12, v20, v14
  v_dot2c_f32_bf16 v13, v20, v20
  v_dot2c_f32_bf16 v12, v21, v14
  v_dot2c_f32_bf16 v13, v21, v21
  v_dot2c_f32_bf16 v12, v22, v14
  v_dot2c_f32_bf16 v13, v22, v22
  v_dot2c_f32_bf16 v12, v23, v14
  v_dot2c_f32_bf16 v13, v23, v23
  v_dot2c_f32_bf16 v12, v24, v14
  v_dot2c_f32_bf16 v13, v24, v24
  v_dot2c_f32_bf16 v12, v25, v14
  v_dot2c_f32_bf16 v13, v25, v25
  v_dot2c_f32_bf16 v12, v26, v14
  v_dot2c_f32_bf16 v13, v26, v26
  v_dot2c_f32_bf16 v12, v27, v14
  v_dot2c_f32_bf16 v13, v27, v27
  v_dot2c_f32_bf16 v12, v28, v14
  v_dot2c_f32_bf16 v13, v28, v28
  v_dot2c_f32_bf16 v12, v29, v14
  v_dot2c_f32_bf16 v13, v29, v29
  v_dot2c_f32_bf16 v12, v30, v14
  v_dot2c_f32_bf16 v13, v30, v30
  v_dot2c_f32_bf16 v12, v31, v14
  v_dot2c_f32_bf16 v13, v31, v31
  v_dot2c_f32_bf16 v12, v32, v14
  v_dot2c_f32_bf16 v13, v32, v32
  v_dot2c_f32_bf16 v12, v33, v14
  v_dot2c_f32_bf16 v13, v33, v33
  v_dot2c_f32_bf16 v12, v34, v14
  v_dot2c_f32_bf16 v13, v34, v34
  v_dot2c_f32_bf16 v12, v35, v14
  v_dot2c_f32_bf16 v13, v35, v35
  v_dot2c_f32_bf16 v12, v36, v14
  v_dot2c_f32_bf16 v13, v36, v36
  v_dot2c_f32_bf16 v12, v37, v14
  v_dot2c_f32_bf16 v13, v37, v37
  v_dot2c_f32_bf16 v12, v38, v14
  v_dot2c_f32_bf16 v13, v38, v38
  v_dot2c_f32_bf16 v12, v39, v14
  v_dot2c_f32_bf16 v13, v39, v39
  v_dot2c_f32_bf16 v12, v40, v14
  v_dot2c_f32_bf16 v13, v40, v40
  v_dot2c_f32_bf16 v12, v41, v14
  v_dot2c_f32_bf16 v13, v41, v41
  v_dot2c_f32_bf16 v12, v42, v14
  v_dot2c_f32_bf16 v13, v42, v42
  v_dot2c_f32_bf16 v12, v43, v14
  v_dot2c_f32_bf16 v13, v43, v43
  v_dot2c_f32_bf16 v12, v44, v14
  v_dot2c_f32_bf16 v13, v44, v44
  v_dot2c_f32_bf16 v12, v45, v14
  v_dot2c_f32_bf16 v13, v45, v45
  v_dot2c_f32_bf16 v12, v46, v14
  v_dot2c_f32_bf16 v13, v46, v46
  v_dot2c_f32_bf16 v12, v47, v14
  v_dot2c_f32_bf16 v13, v47, v47
  s_nop 4
  v_mov_b32 v15, v12
  s_nop 1
  v_permlane32_swap_b32 v12, v15
  s_nop 1
  v_add_f32 v12, v12, v15
  v_mov_b32 v15, v13
  s_nop 1
  v_permlane32_swap_b32 v13, v15
  s_nop 1
  v_add_f32 v13, v13, v15
  v_cmp_eq_u32 vcc, 0, v4
  s_nop 1
  v_cndmask_b32 v56, 0, v12, vcc
  v_cndmask_b32 v57, 0, v13, vcc
  v_mov_b32 v58, 0
  v_mov_b32 v59, 0
  v_lshlrev_b32 v8, 7, v3
  v_lshl_add_u32 v8, v4, 4, v8
  s_lshl_b32 s40, s34, 12
  s_lshl_b32 s41, s3, 5
  s_add_u32 s40, s40, s41
  s_add_u32 s40, s40, 0x2000000
  buffer_store_dwordx4 v[56:59], v8, s[4:7], s40 offen
prep_end:
  s_endpgm
.globl main_kernel
.p2align 8
.type main_kernel,@function
main_kernel:
  s_cmp_ge_u32 s2, 256
  s_cbranch_scc1 main_end
  s_load_dwordx2 s[16:17], s[0:1], 64
  s_load_dwordx2 s[56:57], s[0:1], 56
  s_load_dwordx2 s[68:69], s[0:1], 48
  s_getreg_b32 s85, hwreg(HW_REG_XCC_ID)
  v_lshrrev_b32 v1, 6, v0
  s_nop 0
  v_readfirstlane_b32 s3, v1
  v_and_b32 v1, 63, v0
  v_and_b32 v2, 31, v1
  v_lshrrev_b32 v3, 5, v1
  v_lshlrev_b32 v4, 4, v1
  s_and_b32 s12, s2, 7
  s_lshr_b32 s13, s2, 3
  s_mov_b32 s14, 0
  s_mov_b32 s19, 0
  s_mov_b32 s18, 1
  s_and_b32 s85, s85, 15
  s_lshr_b32 s22, s13, 4
  s_lshl_b32 s24, s12, 1
  s_add_u32 s22, s22, s24
  s_and_b32 s23, s13, 15
  s_and_b32 s24, s3, 3
  s_lshl_b32 s25, s22, 2
  s_add_u32 s24, s24, s25
  s_lshl_b32 s25, s24, 15
  v_lshlrev_b32 v7, 7, v2
  v_lshl_add_u32 v7, v3, 6, v7
  s_lshl_b32 s31, s24, 12
  s_add_u32 s31, s31, 0x2000000
  v_mov_b32 v9, v4
  v_add_u32 v10, 0x10000, v4
  s_waitcnt lgkmcnt(0)
  s_mov_b32 s4, s16
  s_and_b32 s5, s17, 0xffff
  s_mov_b32 s6, 0x10000000
  s_mov_b32 s7, 0x20000
  s_mov_b32 s72, s56
  s_and_b32 s73, s57, 0xffff
  s_mov_b32 s74, 0x100
  s_mov_b32 s75, 0x20000
main_nn:
  s_mov_b32 s15, 0
  s_cmp_eq_u32 s3, 0
  s_cbranch_scc0 main_nx
  s_lshl_b32 s86, s12, 7
  s_lshl_b32 s87, s13, 2
  s_add_u32 s86, s86, s87
  s_add_u32 s86, s86, 0x2200000
  s_add_u32 s87, s85, 128
  v_mov_b32 v5, s87
  v_mov_b32 v6, 0
  s_mov_b64 exec, 1
  buffer_store_dword v5, v6, s[4:7], s86 offen sc1
  s_mov_b64 exec, -1
main_nx:
  s_mov_b32 s8, s68
  s_and_b32 s9, s69, 0xffff
  s_mov_b32 s10, 0x200000
  s_mov_b32 s11, 0x20000
  s_cmp_lt_u32 s3, 4
  s_cbranch_scc1 main_q
  s_lshr_b32 s22, s13, 4
  s_lshl_b32 s24, s12, 1
  s_add_u32 s22, s22, s24
  s_and_b32 s23, s13, 15
  s_sub_u32 s30, s3, 4
  s_lshl_b32 s30, s30, 10
  s_add_u32 s26, s23, 0
  s_lshl_b32 s26, s26, 15
  s_add_u32 s26, s26, s30
  s_add_u32 s26, s26, 0x1800000
  s_add_u32 s27, s23, 16
  s_lshl_b32 s27, s27, 15
  s_add_u32 s27, s27, s30
  s_add_u32 s27, s27, 0x1800000
  s_add_u32 s28, s23, 32
  s_lshl_b32 s28, s28, 15
  s_add_u32 s28, s28, s30
  s_add_u32 s28, s28, 0x1800000
  s_cmp_eq_u32 s3, 4
  s_cbranch_scc0 cs_1
  s_add_u32 s40, s23, 0
  s_add_u32 s41, s23, 16
  s_add_u32 s42, s23, 32
  s_add_u32 s43, s23, 32
  v_mov_b32 v5, s40
  v_mov_b32 v6, s41
  v_cmp_eq_u32 vcc, 0, v3
  v_mov_b32 v7, s42
  v_mov_b32 v8, s43
  v_cndmask_b32 v5, v6, v5, vcc
  v_cndmask_b32 v6, v8, v7, vcc
  v_lshlrev_b32 v5, 7, v5
  v_lshlrev_b32 v6, 7, v6
  v_lshl_add_u32 v5, v2, 2, v5
  v_lshl_add_u32 v6, v2, 2, v6
  s_mov_b32 s33, 0x1f00000
  s_mov_b32 m0, 0x18000
  s_nop 0
  buffer_load_dword v5, s[4:7], s33 offen lds
  s_mov_b32 m0, 0x18100
  s_nop 0
  buffer_load_dword v6, s[4:7], s33 offen lds
cs_1:
  s_add_u32 m0, s30, 0x0
  s_add_u32 s34, s26, 0x0
  buffer_load_dwordx4 v4, s[4:7], s34 offen lds
  s_add_u32 m0, s30, 0x1000
  s_add_u32 s34, s27, 0x0
  buffer_load_dwordx4 v4, s[4:7], s34 offen lds
  s_add_u32 m0, s30, 0x2000
  s_add_u32 s34, s28, 0x0
  buffer_load_dwordx4 v4, s[4:7], s34 offen lds
  s_add_u32 m0, s30, 0x3000
  s_add_u32 s34, s26, 0x1000
  buffer_load_dwordx4 v4, s[4:7], s34 offen lds
  s_add_u32 m0, s30, 0x4000
  s_add_u32 s34, s27, 0x1000
  buffer_load_dwordx4 v4, s[4:7], s34 offen lds
  s_add_u32 m0, s30, 0x5000
  s_add_u32 s34, s28, 0x1000
  buffer_load_dwordx4 v4, s[4:7], s34 offen lds
  s_add_u32 m0, s30, 0x6000
  s_add_u32 s34, s26, 0x2000
  buffer_load_dwordx4 v4, s[4:7], s34 offen lds
  s_add_u32 m0, s30, 0x7000
  s_add_u32 s34, s27, 0x2000
  buffer_load_dwordx4 v4, s[4:7], s34 offen lds
  s_add_u32 m0, s30, 0x8000
  s_add_u32 s34, s28, 0x2000
  buffer_load_dwordx4 v4, s[4:7], s34 offen lds
  s_add_u32 m0, s30, 0x9000
  s_add_u32 s34, s26, 0x3000
  buffer_load_dwordx4 v4, s[4:7], s34 offen lds
  s_add_u32 m0, s30, 0xa000
  s_add_u32 s34, s27, 0x3000
  buffer_load_dwordx4 v4, s[4:7], s34 offen lds
  s_add_u32 m0, s30, 0xb000
  s_add_u32 s34, s28, 0x3000
  buffer_load_dwordx4 v4, s[4:7], s34 offen lds
main_q:
L_qkv:
  s_cmp_ge_u32 s3, 4
  s_cbranch_scc1 qkv_S
  buffer_load_dwordx4 a[104:107], v4, s[4:7], s25 offen offset:0 sc1
  buffer_load_dwordx4 a[108:111], v4, s[4:7], s25 offen offset:1024 sc1
  buffer_load_dwordx4 a[112:115], v4, s[4:7], s25 offen offset:2048 sc1
  buffer_load_dwordx4 a[116:119], v4, s[4:7], s25 offen offset:3072 sc1
  s_add_u32 s25, s25, 4096
  buffer_load_dwordx4 a[120:123], v4, s[4:7], s25 offen offset:0 sc1
  buffer_load_dwordx4 a[124:127], v4, s[4:7], s25 offen offset:1024 sc1
  buffer_load_dwordx4 v[12:15], v7, s[4:7], s31 offen offset:0 sc1
  buffer_load_dwordx4 v[16:19], v7, s[4:7], s31 offen offset:16 sc1
  buffer_load_dwordx4 v[20:23], v7, s[4:7], s31 offen offset:32 sc1
  buffer_load_dwordx4 v[24:27], v7, s[4:7], s31 offen offset:48 sc1
  s_barrier
  ds_read_b128 v[92:95], v9 offset:0
  ds_read_b128 v[96:99], v9 offset:4096
  ds_read_b128 v[100:103], v9 offset:8192
  ds_read_b128 v[104:107], v9 offset:1024
  ds_read_b128 v[108:111], v9 offset:5120
  ds_read_b128 v[112:115], v9 offset:9216
  ds_read_b128 v[116:119], v9 offset:2048
  s_waitcnt vmcnt(9)
  s_waitcnt lgkmcnt(6)
  v_mfma_f32_32x32x16_bf16 v[28:43], v[92:95], a[104:107], 0
  ds_read_b128 v[120:123], v9 offset:6144
  s_waitcnt lgkmcnt(6)
  v_mfma_f32_32x32x16_bf16 v[44:59], v[96:99], a[104:107], 0
  ds_read_b128 v[92:95], v9 offset:10240
  s_waitcnt lgkmcnt(6)
  v_mfma_f32_32x32x16_bf16 v[60:75], a[104:107], v[100:103], 0
  ds_read_b128 v[96:99], v9 offset:3072
  s_waitcnt vmcnt(8)
  s_waitcnt lgkmcnt(6)
  v_mfma_f32_32x32x16_bf16 v[28:43], v[104:107], a[108:111], v[28:43]
  ds_read_b128 v[100:103], v9 offset:7168
  buffer_load_dwordx4 a[104:107], v4, s[4:7], s25 offen offset:2048 sc1
  s_waitcnt lgkmcnt(6)
  v_mfma_f32_32x32x16_bf16 v[44:59], v[108:111], a[108:111], v[44:59]
  ds_read_b128 v[104:107], v9 offset:11264
  s_waitcnt lgkmcnt(6)
  v_mfma_f32_32x32x16_bf16 v[60:75], a[108:111], v[112:115], v[60:75]
  ds_read_b128 v[108:111], v9 offset:12288
  s_waitcnt vmcnt(8)
  s_waitcnt lgkmcnt(6)
  v_mfma_f32_32x32x16_bf16 v[28:43], v[116:119], a[112:115], v[28:43]
  ds_read_b128 v[112:115], v9 offset:16384
  buffer_load_dwordx4 a[108:111], v4, s[4:7], s25 offen offset:3072 sc1
  s_waitcnt lgkmcnt(6)
  v_mfma_f32_32x32x16_bf16 v[44:59], v[120:123], a[112:115], v[44:59]
  ds_read_b128 v[116:119], v9 offset:20480
  s_waitcnt lgkmcnt(6)
  v_mfma_f32_32x32x16_bf16 v[60:75], a[112:115], v[92:95], v[60:75]
  ds_read_b128 v[120:123], v9 offset:13312
  s_barrier
  s_waitcnt vmcnt(8)
  s_waitcnt lgkmcnt(6)
  v_mfma_f32_32x32x16_bf16 v[28:43], v[96:99], a[116:119], v[28:43]
  ds_read_b128 v[92:95], v9 offset:17408
  s_add_u32 s25, s25, 4096
  buffer_load_dwordx4 a[112:115], v4, s[4:7], s25 offen offset:0 sc1
  s_waitcnt lgkmcnt(6)
  v_mfma_f32_32x32x16_bf16 v[44:59], v[100:103], a[116:119], v[44:59]
  ds_read_b128 v[96:99], v9 offset:21504
  s_waitcnt lgkmcnt(6)
  v_mfma_f32_32x32x16_bf16 v[60:75], a[116:119], v[104:107], v[60:75]
  ds_read_b128 v[100:103], v9 offset:14336
  s_waitcnt vmcnt(8)
  s_waitcnt lgkmcnt(6)
  v_mfma_f32_32x32x16_bf16 v[28:43], v[108:111], a[120:123], v[28:43]
  ds_read_b128 v[104:107], v9 offset:18432
  buffer_load_dwordx4 a[116:119], v4, s[4:7], s25 offen offset:1024 sc1
  s_waitcnt lgkmcnt(6)
  v_mfma_f32_32x32x16_bf16 v[44:59], v[112:115], a[120:123], v[44:59]
  ds_read_b128 v[108:111], v9 offset:22528
  s_waitcnt lgkmcnt(6)
  v_mfma_f32_32x32x16_bf16 v[60:75], a[120:123], v[116:119], v[60:75]
  ds_read_b128 v[112:115], v9 offset:15360
  s_waitcnt vmcnt(8)
  s_waitcnt lgkmcnt(6)
  v_mfma_f32_32x32x16_bf16 v[28:43], v[120:123], a[124:127], v[28:43]
  ds_read_b128 v[116:119], v9 offset:19456
  buffer_load_dwordx4 a[120:123], v4, s[4:7], s25 offen offset:2048 sc1
  s_waitcnt lgkmcnt(6)
  v_mfma_f32_32x32x16_bf16 v[44:59], v[92:95], a[124:127], v[44:59]
  ds_read_b128 v[120:123], v9 offset:23552
  s_waitcnt lgkmcnt(6)
  v_mfma_f32_32x32x16_bf16 v[60:75], a[124:127], v[96:99], v[60:75]
  s_barrier
  ds_read_b128 v[92:95], v9 offset:24576
  s_waitcnt vmcnt(4)
  s_waitcnt lgkmcnt(6)
  v_mfma_f32_32x32x16_bf16 v[28:43], v[100:103], a[104:107], v[28:43]
  ds_read_b128 v[96:99], v9 offset:28672
  buffer_load_dwordx4 a[124:127], v4, s[4:7], s25 offen offset:3072 sc1
  s_waitcnt lgkmcnt(6)
  v_mfma_f32_32x32x16_bf16 v[44:59], v[104:107], a[104:107], v[44:59]
  ds_read_b128 v[100:103], v9 offset:32768
  s_waitcnt lgkmcnt(6)
  v_mfma_f32_32x32x16_bf16 v[60:75], a[104:107], v[108:111], v[60:75]
  ds_read_b128 v[104:107], v9 offset:25600
  s_waitcnt vmcnt(4)
  s_waitcnt lgkmcnt(6)
  v_mfma_f32_32x32x16_bf16 v[28:43], v[112:115], a[108:111], v[28:43]
  ds_read_b128 v[108:111], v9 offset:29696
  s_add_u32 s25, s25, 4096
  buffer_load_dwordx4 a[104:107], v4, s[4:7], s25 offen offset:0 sc1
  s_waitcnt lgkmcnt(6)
  v_mfma_f32_32x32x16_bf16 v[44:59], v[116:119], a[108:111], v[44:59]
  ds_read_b128 v[112:115], v9 offset:33792
  s_waitcnt lgkmcnt(6)
  v_mfma_f32_32x32x16_bf16 v[60:75], a[108:111], v[120:123], v[60:75]
  ds_read_b128 v[116:119], v9 offset:26624
  s_waitcnt vmcnt(4)
  s_waitcnt lgkmcnt(6)
  v_mfma_f32_32x32x16_bf16 v[28:43], v[92:95], a[112:115], v[28:43]
  ds_read_b128 v[120:123], v9 offset:30720
  buffer_load_dwordx4 a[108:111], v4, s[4:7], s25 offen offset:1024 sc1
  s_waitcnt lgkmcnt(6)
  v_mfma_f32_32x32x16_bf16 v[44:59], v[96:99], a[112:115], v[44:59]
  ds_read_b128 v[92:95], v9 offset:34816
  s_waitcnt vmcnt(8)
  v_add_f32 v5, v12, v14
  v_add_f32 v6, v13, v15
  s_waitcnt lgkmcnt(6)
  v_mfma_f32_32x32x16_bf16 v[60:75], a[112:115], v[100:103], v[60:75]
  ds_read_b128 v[96:99], v9 offset:27648
  v_add_f32 v5, v5, v16
  v_add_f32 v6, v6, v17
  s_waitcnt vmcnt(4)
  s_waitcnt lgkmcnt(6)
  v_mfma_f32_32x32x16_bf16 v[28:43], v[104:107], a[116:119], v[28:43]
  ds_read_b128 v[100:103], v9 offset:31744
  buffer_load_dwordx4 a[112:115], v4, s[4:7], s25 offen offset:2048 sc1
  s_waitcnt lgkmcnt(6)
  v_mfma_f32_32x32x16_bf16 v[44:59], v[108:111], a[116:119], v[44:59]
  ds_read_b128 v[104:107], v9 offset:35840
  v_add_f32 v5, v5, v18
  v_add_f32 v6, v6, v19
  s_waitcnt lgkmcnt(6)
  v_mfma_f32_32x32x16_bf16 v[60:75], a[116:119], v[112:115], v[60:75]
  ds_read_b128 v[108:111], v9 offset:36864
  v_add_f32 v5, v5, v20
  v_add_f32 v6, v6, v21
  s_waitcnt vmcnt(4)
  s_waitcnt lgkmcnt(6)
  v_mfma_f32_32x32x16_bf16 v[28:43], v[116:119], a[120:123], v[28:43]
  ds_read_b128 v[112:115], v9 offset:40960
  buffer_load_dwordx4 a[116:119], v4, s[4:7], s25 offen offset:3072 sc1
  s_waitcnt lgkmcnt(6)
  v_mfma_f32_32x32x16_bf16 v[44:59], v[120:123], a[120:123], v[44:59]
  ds_read_b128 v[116:119], v9 offset:45056
  v_add_f32 v5, v5, v22
  v_add_f32 v6, v6, v23
  s_waitcnt lgkmcnt(6)
  v_mfma_f32_32x32x16_bf16 v[60:75], a[120:123], v[92:95], v[60:75]
  ds_read_b128 v[120:123], v9 offset:37888
  v_add_f32 v5, v5, v24
  v_add_f32 v6, v6, v25
  s_waitcnt vmcnt(4)
  s_waitcnt lgkmcnt(6)
  v_mfma_f32_32x32x16_bf16 v[28:43], v[96:99], a[124:127], v[28:43]
  ds_read_b128 v[92:95], v9 offset:41984
  s_add_u32 s25, s25, 4096
  buffer_load_dwordx4 a[120:123], v4, s[4:7], s25 offen offset:0 sc1
  s_waitcnt lgkmcnt(6)
  v_mfma_f32_32x32x16_bf16 v[44:59], v[100:103], a[124:127], v[44:59]
  ds_read_b128 v[96:99], v9 offset:46080
  v_add_f32 v5, v5, v26
  v_add_f32 v6, v6, v27
  s_waitcnt lgkmcnt(6)
  v_mfma_f32_32x32x16_bf16 v[60:75], a[124:127], v[104:107], v[60:75]
  ds_read_b128 v[100:103], v9 offset:38912
  v_mov_b32 v8, v5
  s_nop 1
  s_waitcnt vmcnt(4)
  s_waitcnt lgkmcnt(6)
  v_mfma_f32_32x32x16_bf16 v[28:43], v[108:111], a[104:107], v[28:43]
  ds_read_b128 v[104:107], v9 offset:43008
  buffer_load_dwordx4 a[124:127], v4, s[4:7], s25 offen offset:1024 sc1
  s_waitcnt lgkmcnt(6)
  v_mfma_f32_32x32x16_bf16 v[44:59], v[112:115], a[104:107], v[44:59]
  ds_read_b128 v[108:111], v9 offset:47104
  v_permlane32_swap_b32 v5, v8
  s_nop 1
  s_waitcnt lgkmcnt(6)
  v_mfma_f32_32x32x16_bf16 v[60:75], a[104:107], v[116:119], v[60:75]
  ds_read_b128 v[112:115], v9 offset:39936
  v_add_f32 v5, v5, v8
  s_waitcnt vmcnt(4)
  s_waitcnt lgkmcnt(6)
  v_mfma_f32_32x32x16_bf16 v[28:43], v[120:123], a[108:111], v[28:43]
  ds_read_b128 v[116:119], v9 offset:44032
  buffer_load_dwordx4 a[104:107], v4, s[4:7], s25 offen offset:2048 sc1
  s_waitcnt lgkmcnt(6)
  v_mfma_f32_32x32x16_bf16 v[44:59], v[92:95], a[108:111], v[44:59]
  ds_read_b128 v[120:123], v9 offset:48128
  v_mov_b32 v8, v6
  s_nop 1
  s_waitcnt lgkmcnt(6)
  v_mfma_f32_32x32x16_bf16 v[60:75], a[108:111], v[96:99], v[60:75]
  s_barrier
  ds_read_b128 v[92:95], v9 offset:49152
  v_permlane32_swap_b32 v6, v8
  s_nop 1
  s_waitcnt vmcnt(4)
  s_waitcnt lgkmcnt(6)
  v_mfma_f32_32x32x16_bf16 v[28:43], v[100:103], a[112:115], v[28:43]
  ds_read_b128 v[96:99], v9 offset:53248
  buffer_load_dwordx4 a[108:111], v4, s[4:7], s25 offen offset:3072 sc1
  s_waitcnt lgkmcnt(6)
  v_mfma_f32_32x32x16_bf16 v[44:59], v[104:107], a[112:115], v[44:59]
  ds_read_b128 v[100:103], v9 offset:57344
  v_add_f32 v6, v6, v8
  s_waitcnt lgkmcnt(6)
  v_mfma_f32_32x32x16_bf16 v[60:75], a[112:115], v[108:111], v[60:75]
  ds_read_b128 v[104:107], v9 offset:50176
  v_mul_f32 v5, 0x3b000000, v5
  v_mul_f32 v6, 0x3b000000, v6
  s_waitcnt vmcnt(4)
  s_waitcnt lgkmcnt(6)
  v_mfma_f32_32x32x16_bf16 v[28:43], v[112:115], a[116:119], v[28:43]
  ds_read_b128 v[108:111], v9 offset:54272
  s_add_u32 s25, s25, 4096
  buffer_load_dwordx4 a[112:115], v4, s[4:7], s25 offen offset:0 sc1
  s_waitcnt lgkmcnt(6)
  v_mfma_f32_32x32x16_bf16 v[44:59], v[116:119], a[116:119], v[44:59]
  ds_read_b128 v[112:115], v9 offset:58368
  v_fma_f32 v6, -v5, v5, v6
  v_sub_f32 v12, 0, v5
  s_waitcnt lgkmcnt(6)
  v_mfma_f32_32x32x16_bf16 v[60:75], a[116:119], v[120:123], v[60:75]
  ds_read_b128 v[116:119], v9 offset:51200
  v_max_f32 v6, 0, v6
  v_lshlrev_b32 v18, 4, v3
  s_waitcnt vmcnt(4)
  s_waitcnt lgkmcnt(6)
  v_mfma_f32_32x32x16_bf16 v[28:43], v[92:95], a[120:123], v[28:43]
  ds_read_b128 v[120:123], v9 offset:55296
  buffer_load_dwordx4 a[116:119], v4, s[4:7], s25 offen offset:1024 sc1
  s_waitcnt lgkmcnt(6)
  v_mfma_f32_32x32x16_bf16 v[44:59], v[96:99], a[120:123], v[44:59]
  ds_read_b128 v[92:95], v9 offset:59392
  v_add_f32 v6, 0x3727c5ac, v6
  v_add_u32 v19, 0x18000, v18
  s_waitcnt lgkmcnt(6)
  v_mfma_f32_32x32x16_bf16 v[60:75], a[120:123], v[100:103], v[60:75]
  ds_read_b128 v[96:99], v9 offset:52224
  v_rsq_f32 v14, v6
  s_nop 0
  s_waitcnt vmcnt(4)
  s_waitcnt lgkmcnt(6)
  v_mfma_f32_32x32x16_bf16 v[28:43], v[104:107], a[124:127], v[28:43]
  ds_read_b128 v[100:103], v9 offset:56320
  buffer_load_dwordx4 a[120:123], v4, s[4:7], s25 offen offset:2048 sc1
  s_waitcnt lgkmcnt(6)
  v_mfma_f32_32x32x16_bf16 v[44:59], v[108:111], a[124:127], v[44:59]
  ds_read_b128 v[104:107], v9 offset:60416
  v_mul_f32 v16, 0x3eb8aa3b, v14
  s_waitcnt lgkmcnt(6)
  v_mfma_f32_32x32x16_bf16 v[60:75], a[124:127], v[112:115], v[60:75]
  ds_read_b128 v[108:111], v9 offset:61440
  s_waitcnt vmcnt(4)
  s_waitcnt lgkmcnt(6)
  v_mfma_f32_32x32x16_bf16 v[28:43], v[116:119], a[104:107], v[28:43]
  ds_read_b128 v[112:115], v10 offset:0
  buffer_load_dwordx4 a[124:127], v4, s[4:7], s25 offen offset:3072 sc1
  s_waitcnt lgkmcnt(6)
  v_mfma_f32_32x32x16_bf16 v[44:59], v[120:123], a[104:107], v[44:59]
  ds_read_b128 v[116:119], v10 offset:4096
  s_waitcnt lgkmcnt(6)
  v_mfma_f32_32x32x16_bf16 v[60:75], a[104:107], v[92:95], v[60:75]
  ds_read_b128 v[120:123], v9 offset:62464
  s_waitcnt vmcnt(4)
  s_waitcnt lgkmcnt(6)
  v_mfma_f32_32x32x16_bf16 v[28:43], v[96:99], a[108:111], v[28:43]
  ds_read_b128 v[92:95], v10 offset:1024
  s_add_u32 s25, s25, 4096
  buffer_load_dwordx4 a[104:107], v4, s[4:7], s25 offen offset:0 sc1
  s_waitcnt lgkmcnt(6)
  v_mfma_f32_32x32x16_bf16 v[44:59], v[100:103], a[108:111], v[44:59]
  ds_read_b128 v[96:99], v10 offset:5120
  s_waitcnt lgkmcnt(6)
  v_mfma_f32_32x32x16_bf16 v[60:75], a[108:111], v[104:107], v[60:75]
  ds_read_b128 v[100:103], v9 offset:63488
  s_waitcnt vmcnt(4)
  s_waitcnt lgkmcnt(6)
  v_mfma_f32_32x32x16_bf16 v[28:43], v[108:111], a[112:115], v[28:43]
  ds_read_b128 v[104:107], v10 offset:2048
  buffer_load_dwordx4 a[108:111], v4, s[4:7], s25 offen offset:1024 sc1
  s_waitcnt lgkmcnt(6)
  v_mfma_f32_32x32x16_bf16 v[44:59], v[112:115], a[112:115], v[44:59]
  ds_read_b128 v[108:111], v10 offset:6144
  s_waitcnt lgkmcnt(6)
  v_mfma_f32_32x32x16_bf16 v[60:75], a[112:115], v[116:119], v[60:75]
  ds_read_b128 v[112:115], v9 offset:64512
  s_waitcnt vmcnt(4)
  s_waitcnt lgkmcnt(6)
  v_mfma_f32_32x32x16_bf16 v[28:43], v[120:123], a[116:119], v[28:43]
  ds_read_b128 v[116:119], v10 offset:3072
  buffer_load_dwordx4 a[112:115], v4, s[4:7], s25 offen offset:2048 sc1
  s_waitcnt lgkmcnt(6)
  v_mfma_f32_32x32x16_bf16 v[44:59], v[92:95], a[116:119], v[44:59]
  ds_read_b128 v[120:123], v10 offset:7168
  s_waitcnt lgkmcnt(6)
  v_mfma_f32_32x32x16_bf16 v[60:75], a[116:119], v[96:99], v[60:75]
  s_barrier
  ds_read_b128 v[92:95], v10 offset:8192
  s_waitcnt vmcnt(4)
  s_waitcnt lgkmcnt(6)
  v_mfma_f32_32x32x16_bf16 v[28:43], v[100:103], a[120:123], v[28:43]
  ds_read_b128 v[96:99], v10 offset:12288
  buffer_load_dwordx4 a[116:119], v4, s[4:7], s25 offen offset:3072 sc1
  s_waitcnt lgkmcnt(6)
  v_mfma_f32_32x32x16_bf16 v[44:59], v[104:107], a[120:123], v[44:59]
  ds_read_b128 v[100:103], v10 offset:16384
  s_waitcnt lgkmcnt(6)
  v_mfma_f32_32x32x16_bf16 v[60:75], a[120:123], v[108:111], v[60:75]
  ds_read_b128 v[104:107], v10 offset:9216
  s_waitcnt vmcnt(4)
  s_waitcnt lgkmcnt(6)
  v_mfma_f32_32x32x16_bf16 v[28:43], v[112:115], a[124:127], v[28:43]
  ds_read_b128 v[108:111], v10 offset:13312
  s_add_u32 s25, s25, 4096
  buffer_load_dwordx4 a[120:123], v4, s[4:7], s25 offen offset:0 sc1
  s_waitcnt lgkmcnt(6)
  v_mfma_f32_32x32x16_bf16 v[44:59], v[116:119], a[124:127], v[44:59]
  ds_read_b128 v[112:115], v10 offset:17408
  s_waitcnt lgkmcnt(6)
  v_mfma_f32_32x32x16_bf16 v[60:75], a[124:127], v[120:123], v[60:75]
  ds_read_b128 v[116:119], v10 offset:10240
  s_waitcnt vmcnt(4)
  s_waitcnt lgkmcnt(6)
  v_mfma_f32_32x32x16_bf16 v[28:43], v[92:95], a[104:107], v[28:43]
  ds_read_b128 v[120:123], v10 offset:14336
  buffer_load_dwordx4 a[124:127], v4, s[4:7], s25 offen offset:1024 sc1
  s_waitcnt lgkmcnt(6)
  v_mfma_f32_32x32x16_bf16 v[44:59], v[96:99], a[104:107], v[44:59]
  ds_read_b128 v[92:95], v10 offset:18432
  s_waitcnt lgkmcnt(6)
  v_mfma_f32_32x32x16_bf16 v[60:75], a[104:107], v[100:103], v[60:75]
  ds_read_b128 v[96:99], v10 offset:11264
  s_waitcnt vmcnt(4)
  s_waitcnt lgkmcnt(6)
  v_mfma_f32_32x32x16_bf16 v[28:43], v[104:107], a[108:111], v[28:43]
  ds_read_b128 v[100:103], v10 offset:15360
  buffer_load_dwordx4 a[104:107], v4, s[4:7], s25 offen offset:2048 sc1
  s_waitcnt lgkmcnt(6)
  v_mfma_f32_32x32x16_bf16 v[44:59], v[108:111], a[108:111], v[44:59]
  ds_read_b128 v[104:107], v10 offset:19456
  s_waitcnt lgkmcnt(6)
  v_mfma_f32_32x32x16_bf16 v[60:75], a[108:111], v[112:115], v[60:75]
  ds_read_b128 v[108:111], v10 offset:20480
  s_waitcnt vmcnt(4)
  s_waitcnt lgkmcnt(6)
  v_mfma_f32_32x32x16_bf16 v[28:43], v[116:119], a[112:115], v[28:43]
  ds_read_b128 v[112:115], v10 offset:24576
  buffer_load_dwordx4 a[108:111], v4, s[4:7], s25 offen offset:3072 sc1
  s_waitcnt lgkmcnt(6)
  v_mfma_f32_32x32x16_bf16 v[44:59], v[120:123], a[112:115], v[44:59]
  ds_read_b128 v[116:119], v10 offset:28672
  s_waitcnt lgkmcnt(6)
  v_mfma_f32_32x32x16_bf16 v[60:75], a[112:115], v[92:95], v[60:75]
  ds_read_b128 v[120:123], v10 offset:21504
  s_waitcnt vmcnt(4)
  s_waitcnt lgkmcnt(6)
  v_mfma_f32_32x32x16_bf16 v[28:43], v[96:99], a[116:119], v[28:43]
  ds_read_b128 v[92:95], v10 offset:25600
  s_waitcnt lgkmcnt(6)
  v_mfma_f32_32x32x16_bf16 v[44:59], v[100:103], a[116:119], v[44:59]
  ds_read_b128 v[96:99], v10 offset:29696
  s_waitcnt lgkmcnt(6)
  v_mfma_f32_32x32x16_bf16 v[60:75], a[116:119], v[104:107], v[60:75]
  ds_read_b128 v[100:103], v10 offset:22528
  s_waitcnt vmcnt(3)
  s_waitcnt lgkmcnt(6)
  v_mfma_f32_32x32x16_bf16 v[28:43], v[108:111], a[120:123], v[28:43]
  ds_read_b128 v[104:107], v10 offset:26624
  s_waitcnt lgkmcnt(6)
  v_mfma_f32_32x32x16_bf16 v[44:59], v[112:115], a[120:123], v[44:59]
  ds_read_b128 v[108:111], v10 offset:30720
  s_waitcnt lgkmcnt(6)
  v_mfma_f32_32x32x16_bf16 v[60:75], a[120:123], v[116:119], v[60:75]
  ds_read_b128 v[112:115], v10 offset:23552
  s_waitcnt vmcnt(2)
  s_waitcnt lgkmcnt(6)
  v_mfma_f32_32x32x16_bf16 v[28:43], v[120:123], a[124:127], v[28:43]
  ds_read_b128 v[116:119], v10 offset:27648
  s_waitcnt lgkmcnt(6)
  v_mfma_f32_32x32x16_bf16 v[44:59], v[92:95], a[124:127], v[44:59]
  ds_read_b128 v[120:123], v10 offset:31744
  s_waitcnt lgkmcnt(6)
  v_mfma_f32_32x32x16_bf16 v[60:75], a[124:127], v[96:99], v[60:75]
  s_waitcnt vmcnt(1)
  s_waitcnt lgkmcnt(5)
  v_mfma_f32_32x32x16_bf16 v[28:43], v[100:103], a[104:107], v[28:43]
  s_waitcnt lgkmcnt(4)
  v_mfma_f32_32x32x16_bf16 v[44:59], v[104:107], a[104:107], v[44:59]
  s_waitcnt lgkmcnt(3)
  v_mfma_f32_32x32x16_bf16 v[60:75], a[104:107], v[108:111], v[60:75]
  s_waitcnt vmcnt(0)
  s_waitcnt lgkmcnt(2)
  v_mfma_f32_32x32x16_bf16 v[28:43], v[112:115], a[108:111], v[28:43]
  s_waitcnt lgkmcnt(1)
  v_mfma_f32_32x32x16_bf16 v[44:59], v[116:119], a[108:111], v[44:59]
  s_waitcnt lgkmcnt(0)
  v_mfma_f32_32x32x16_bf16 v[60:75], a[108:111], v[120:123], v[60:75]
  s_lshl_b32 s34, s23, 7
  s_add_u32 s34, s34, s24
  s_lshl_b32 s34, s34, 10
  ds_read_b128 v[92:95], v19 offset:128
  ds_read_b128 v[96:99], v19 offset:160
  ds_read_b128 v[100:103], v19 offset:192
  ds_read_b128 v[104:107], v19 offset:224
  s_waitcnt lgkmcnt(0)
  s_nop 7
  s_nop 3
  v_pk_fma_f32 v[44:45], v[92:93], v[12:13], v[44:45] op_sel_hi:[1,0,1]
  v_pk_fma_f32 v[46:47], v[94:95], v[12:13], v[46:47] op_sel_hi:[1,0,1]
  v_pk_fma_f32 v[48:49], v[96:97], v[12:13], v[48:49] op_sel_hi:[1,0,1]
  v_pk_fma_f32 v[50:51], v[98:99], v[12:13], v[50:51] op_sel_hi:[1,0,1]
  v_pk_fma_f32 v[52:53], v[100:101], v[12:13], v[52:53] op_sel_hi:[1,0,1]
  v_pk_fma_f32 v[54:55], v[102:103], v[12:13], v[54:55] op_sel_hi:[1,0,1]
  v_pk_fma_f32 v[56:57], v[104:105], v[12:13], v[56:57] op_sel_hi:[1,0,1]
  v_pk_fma_f32 v[58:59], v[106:107], v[12:13], v[58:59] op_sel_hi:[1,0,1]
  v_pk_mul_f32 v[44:45], v[44:45], v[14:15] op_sel_hi:[1,0]
  v_pk_mul_f32 v[46:47], v[46:47], v[14:15] op_sel_hi:[1,0]
  v_pk_mul_f32 v[48:49], v[48:49], v[14:15] op_sel_hi:[1,0]
  v_pk_mul_f32 v[50:51], v[50:51], v[14:15] op_sel_hi:[1,0]
  v_pk_mul_f32 v[52:53], v[52:53], v[14:15] op_sel_hi:[1,0]
  v_pk_mul_f32 v[54:55], v[54:55], v[14:15] op_sel_hi:[1,0]
  v_pk_mul_f32 v[56:57], v[56:57], v[14:15] op_sel_hi:[1,0]
  v_pk_mul_f32 v[58:59], v[58:59], v[14:15] op_sel_hi:[1,0]
  v_cvt_pk_bf16_f32 v44, v44, v45
  v_cvt_pk_bf16_f32 v45, v46, v47
  v_cvt_pk_bf16_f32 v46, v48, v49
  v_cvt_pk_bf16_f32 v47, v50, v51
  v_cvt_pk_bf16_f32 v48, v52, v53
  v_cvt_pk_bf16_f32 v49, v54, v55
  v_cvt_pk_bf16_f32 v50, v56, v57
  v_cvt_pk_bf16_f32 v51, v58, v59
  s_add_u32 s35, s34, 0xa00000
  s_add_u32 s35, s35, s19
  s_add_u32 s36, s35, 0x10000
  buffer_store_dwordx4 v[44:47], v4, s[4:7], s35 offen sc1
  buffer_store_dwordx4 v[48:51], v4, s[4:7], s36 offen sc1
  v_lshlrev_b32 v20, 2, v2
  s_lshl_b32 s35, s3, 8
  s_add_u32 s35, s35, 0x18200
  v_add_u32 v21, s35, v20
  ds_write_b32 v21, v12
  ds_write_b32 v21, v14 offset:128
  v_add_u32 v22, s35, v18
  v_add_u32 v23, 0x18000, v20
  s_waitcnt lgkmcnt(0)
  ds_read_b128 v[92:95], v22 offset:0
  ds_read_b128 v[96:99], v22 offset:32
  ds_read_b128 v[100:103], v22 offset:64
  ds_read_b128 v[104:107], v22 offset:96
  ds_read_b128 v[108:111], v22 offset:128
  ds_read_b128 v[112:115], v22 offset:160
  ds_read_b128 v[116:119], v22 offset:192
  ds_read_b128 v[120:123], v22 offset:224
  ds_read_b32 v24, v23 offset:256
  s_waitcnt lgkmcnt(0)
  v_pk_fma_f32 v[60:61], v[92:93], v[24:25], v[60:61] op_sel_hi:[1,0,1]
  v_pk_fma_f32 v[62:63], v[94:95], v[24:25], v[62:63] op_sel_hi:[1,0,1]
  v_pk_fma_f32 v[64:65], v[96:97], v[24:25], v[64:65] op_sel_hi:[1,0,1]
  v_pk_fma_f32 v[66:67], v[98:99], v[24:25], v[66:67] op_sel_hi:[1,0,1]
  v_pk_fma_f32 v[68:69], v[100:101], v[24:25], v[68:69] op_sel_hi:[1,0,1]
  v_pk_fma_f32 v[70:71], v[102:103], v[24:25], v[70:71] op_sel_hi:[1,0,1]
  v_pk_fma_f32 v[72:73], v[104:105], v[24:25], v[72:73] op_sel_hi:[1,0,1]
  v_pk_fma_f32 v[74:75], v[106:107], v[24:25], v[74:75] op_sel_hi:[1,0,1]
  v_pk_mul_f32 v[60:61], v[60:61], v[108:109]
  v_pk_mul_f32 v[62:63], v[62:63], v[110:111]
  v_pk_mul_f32 v[64:65], v[64:65], v[112:113]
  v_pk_mul_f32 v[66:67], v[66:67], v[114:115]
  v_pk_mul_f32 v[68:69], v[68:69], v[116:117]
  v_pk_mul_f32 v[70:71], v[70:71], v[118:119]
  v_pk_mul_f32 v[72:73], v[72:73], v[120:121]
  v_pk_mul_f32 v[74:75], v[74:75], v[122:123]
  v_cvt_pk_bf16_f32 v60, v60, v61
  v_cvt_pk_bf16_f32 v61, v62, v63
  v_cvt_pk_bf16_f32 v62, v64, v65
  v_cvt_pk_bf16_f32 v63, v66, v67
  v_cvt_pk_bf16_f32 v64, v68, v69
  v_cvt_pk_bf16_f32 v65, v70, v71
  v_cvt_pk_bf16_f32 v66, v72, v73
  v_cvt_pk_bf16_f32 v67, v74, v75
  v_lshrrev_b32 v26, 4, v2
  v_lshlrev_b32 v26, 16, v26
  v_lshl_add_u32 v26, v3, 8, v26
  v_and_b32 v27, 15, v2
  v_lshl_add_u32 v26, v27, 4, v26
  s_lshl_b32 s35, s23, 17
  s_lshl_b32 s36, s24, 10
  s_add_u32 s35, s35, s36
  s_add_u32 s35, s35, 0xc00000
  s_add_u32 s35, s35, s19
  buffer_store_dwordx4 v[60:63], v26, s[4:7], s35 offen sc1
  buffer_store_dwordx4 v[64:67], v26, s[4:7], s35 offen offset:512 sc1
  ds_read_b128 v[92:95], v19 offset:0
  ds_read_b128 v[96:99], v19 offset:32
  ds_read_b128 v[100:103], v19 offset:64
  ds_read_b128 v[104:107], v19 offset:96
  s_waitcnt lgkmcnt(0)
  v_pk_fma_f32 v[28:29], v[92:93], v[12:13], v[28:29] op_sel_hi:[1,0,1]
  v_pk_fma_f32 v[30:31], v[94:95], v[12:13], v[30:31] op_sel_hi:[1,0,1]
  v_pk_fma_f32 v[32:33], v[96:97], v[12:13], v[32:33] op_sel_hi:[1,0,1]
  v_pk_fma_f32 v[34:35], v[98:99], v[12:13], v[34:35] op_sel_hi:[1,0,1]
  v_pk_fma_f32 v[36:37], v[100:101], v[12:13], v[36:37] op_sel_hi:[1,0,1]
  v_pk_fma_f32 v[38:39], v[102:103], v[12:13], v[38:39] op_sel_hi:[1,0,1]
  v_pk_fma_f32 v[40:41], v[104:105], v[12:13], v[40:41] op_sel_hi:[1,0,1]
  v_pk_fma_f32 v[42:43], v[106:107], v[12:13], v[42:43] op_sel_hi:[1,0,1]
  v_pk_mul_f32 v[28:29], v[28:29], v[16:17] op_sel_hi:[1,0]
  v_pk_mul_f32 v[30:31], v[30:31], v[16:17] op_sel_hi:[1,0]
  v_pk_mul_f32 v[32:33], v[32:33], v[16:17] op_sel_hi:[1,0]
  v_pk_mul_f32 v[34:35], v[34:35], v[16:17] op_sel_hi:[1,0]
  v_pk_mul_f32 v[36:37], v[36:37], v[16:17] op_sel_hi:[1,0]
  v_pk_mul_f32 v[38:39], v[38:39], v[16:17] op_sel_hi:[1,0]
  v_pk_mul_f32 v[40:41], v[40:41], v[16:17] op_sel_hi:[1,0]
  v_pk_mul_f32 v[42:43], v[42:43], v[16:17] op_sel_hi:[1,0]
  v_cvt_pk_bf16_f32 v28, v28, v29
  v_cvt_pk_bf16_f32 v29, v30, v31
  v_cvt_pk_bf16_f32 v30, v32, v33
  v_cvt_pk_bf16_f32 v31, v34, v35
  v_cvt_pk_bf16_f32 v32, v36, v37
  v_cvt_pk_bf16_f32 v33, v38, v39
  v_cvt_pk_bf16_f32 v34, v40, v41
  v_cvt_pk_bf16_f32 v35, v42, v43
  s_add_u32 s35, s34, 0x800000
  s_add_u32 s36, s35, 0x10000
  buffer_store_dwordx4 v[28:31], v4, s[4:7], s35 offen
  buffer_store_dwordx4 v[32:35], v4, s[4:7], s36 offen
  s_lshr_b32 s22, s13, 4
  s_lshl_b32 s24, s12, 1
  s_add_u32 s22, s22, s24
  s_and_b32 s23, s13, 15
  s_lshr_b32 s50, s3, 2
  s_lshl_b32 s51, s23, 2
  s_add_u32 s50, s50, s51
  s_lshl_b32 s50, s50, 15
  s_and_b32 s51, s3, 3
  s_lshl_b32 s51, s51, 10
  s_add_u32 s50, s50, s51
  s_add_u32 s50, s50, 0x1b00000
  s_lshr_b32 s52, s3, 2
  s_lshl_b32 s52, s52, 12
  s_add_u32 s51, s51, s52
  s_lshl_b32 s63, s22, 2
  s_and_b32 s53, s3, 3
  s_add_u32 s63, s63, s53
  s_mul_i32 s63, s63, 112
  s_lshl_b32 s53, s23, 3
  s_add_u32 s63, s63, s53
  s_lshl_b32 s63, s63, 10
  s_add_u32 s63, s63, 0x1000000
  s_and_b32 s54, s13, 7
  s_lshl_b32 s54, s54, 1
  s_and_b32 s55, s3, 1
  s_add_u32 s56, s54, s55
  s_xor_b32 s55, s55, 1
  s_add_u32 s57, s54, s55
  s_mul_i32 s55, s3, 14
  s_mul_i32 s56, s56, 112
  s_add_u32 s56, s56, s55
  s_lshl_b32 s56, s56, 10
  s_add_u32 s56, s56, 0x1d00000
  s_mul_i32 s57, s57, 112
  s_add_u32 s57, s57, s55
  s_lshl_b32 s57, s57, 10
  s_add_u32 s57, s57, 0x1d00000
  s_and_b32 s22, s3, 3
  s_lshr_b32 s23, s3, 2
  s_lshl_b32 s24, s12, 3
  s_lshl_b32 s26, s22, 1
  s_add_u32 s24, s24, s26
  s_lshl_b32 s25, s13, 16
  s_add_u32 s25, s25, s19
  s_lshl_b32 s26, s24, 10
  s_lshl_b32 s27, s13, 16
  s_add_u32 s26, s26, s27
  s_add_u32 s26, s26, 0x800000
  s_lshr_b32 s27, s22, 1
  s_and_b32 s28, s22, 1
  s_mul_i32 s29, s28, 32768
  s_mul_i32 s30, s23, 16384
  s_add_u32 s29, s29, s30
  s_lshl_b32 s30, s27, 10
  s_add_u32 s29, s29, s30
  s_add_u32 s29, s29, 0x14000
  s_mov_b32 s31, 0
  s_mul_i32 s28, s28, 0x200000
  s_lshl_b32 s30, s23, 12
  s_add_u32 s28, s28, s30
  s_lshl_b32 s30, s27, 10
  s_add_u32 s28, s28, s30
  s_add_u32 s28, s28, s25
  s_add_u32 s28, s28, 0xa00000
  s_lshl_b32 s59, s12, 13
  s_movk_i32 s61, 6144
  s_movk_i32 s62, 2048
  s_waitcnt vmcnt(0)
  s_branch qkv_done
qkv_S:
  s_waitcnt vmcnt(6)
  s_barrier
  s_barrier
  s_lshr_b32 s22, s13, 4
  s_lshl_b32 s24, s12, 1
  s_add_u32 s22, s22, s24
  s_and_b32 s23, s13, 15
  s_sub_u32 s30, s3, 4
  s_lshl_b32 s30, s30, 10
  s_add_u32 s26, s23, 0
  s_lshl_b32 s26, s26, 15
  s_add_u32 s26, s26, s30
  s_add_u32 s26, s26, 0x1800000
  s_add_u32 s27, s23, 16
  s_lshl_b32 s27, s27, 15
  s_add_u32 s27, s27, s30
  s_add_u32 s27, s27, 0x1800000
  s_add_u32 s28, s23, 32
  s_lshl_b32 s28, s28, 15
  s_add_u32 s28, s28, s30
  s_add_u32 s28, s28, 0x1800000
  s_cmp_eq_u32 s14, 0
  s_cbranch_scc1 cs_2
  s_cmp_eq_u32 s3, 4
  s_cbranch_scc0 cs_2
  s_add_u32 s40, s23, 0
  s_add_u32 s41, s23, 16
  s_add_u32 s42, s23, 32
  s_add_u32 s43, s23, 32
  v_mov_b32 v5, s40
  v_mov_b32 v6, s41
  v_cmp_eq_u32 vcc, 0, v3
  v_mov_b32 v7, s42
  v_mov_b32 v8, s43
  v_cndmask_b32 v5, v6, v5, vcc
  v_cndmask_b32 v6, v8, v7, vcc
  v_lshlrev_b32 v5, 7, v5
  v_lshlrev_b32 v6, 7, v6
  v_lshl_add_u32 v5, v2, 2, v5
  v_lshl_add_u32 v6, v2, 2, v6
  s_mov_b32 s33, 0x1f00000
  s_mov_b32 m0, 0x18000
  s_nop 0
  buffer_load_dword v5, s[4:7], s33 offen lds
  s_mov_b32 m0, 0x18100
  s_nop 0
  buffer_load_dword v6, s[4:7], s33 offen lds
cs_2:
  s_add_u32 m0, s30, 0xc000
  s_add_u32 s34, s26, 0x4000
  buffer_load_dwordx4 v4, s[4:7], s34 offen lds
  s_add_u32 m0, s30, 0xd000
  s_add_u32 s34, s27, 0x4000
  buffer_load_dwordx4 v4, s[4:7], s34 offen lds
  s_add_u32 m0, s30, 0xe000
  s_add_u32 s34, s28, 0x4000
  buffer_load_dwordx4 v4, s[4:7], s34 offen lds
  s_add_u32 m0, s30, 0xf000
  s_add_u32 s34, s26, 0x5000
  buffer_load_dwordx4 v4, s[4:7], s34 offen lds
  s_add_u32 m0, s30, 0x10000
  s_add_u32 s34, s27, 0x5000
  buffer_load_dwordx4 v4, s[4:7], s34 offen lds
  s_add_u32 m0, s30, 0x11000
  s_add_u32 s34, s28, 0x5000
  buffer_load_dwordx4 v4, s[4:7], s34 offen lds
  s_add_u32 m0, s30, 0x12000
  s_add_u32 s34, s26, 0x6000
  buffer_load_dwordx4 v4, s[4:7], s34 offen lds
  s_add_u32 m0, s30, 0x13000
  s_add_u32 s34, s27, 0x6000
  buffer_load_dwordx4 v4, s[4:7], s34 offen lds
  s_add_u32 m0, s30, 0x14000
  s_add_u32 s34, s28, 0x6000
  buffer_load_dwordx4 v4, s[4:7], s34 offen lds
  s_add_u32 m0, s30, 0x15000
  s_add_u32 s34, s26, 0x7000
  buffer_load_dwordx4 v4, s[4:7], s34 offen lds
  s_add_u32 m0, s30, 0x16000
  s_add_u32 s34, s27, 0x7000
  buffer_load_dwordx4 v4, s[4:7], s34 offen lds
  s_add_u32 m0, s30, 0x17000
  s_add_u32 s34, s28, 0x7000
  buffer_load_dwordx4 v4, s[4:7], s34 offen lds
  s_waitcnt vmcnt(12)
  s_barrier
  s_waitcnt vmcnt(6)
  s_barrier
  s_waitcnt vmcnt(0)
  s_barrier
  s_cmp_eq_u32 s14, 0
  s_cbranch_scc0 qkv_Sfin
  s_cmp_eq_u32 s3, 4
  s_cbranch_scc0 qkv_Sfin
  s_lshl_b32 s86, s12, 7
  s_add_u32 s86, s86, 0x2200000
  v_lshlrev_b32 v8, 2, v1
  s_movk_i32 s87, 128
  s_mov_b32 exec_lo, 0xffffffff
  s_mov_b32 exec_hi, 0
  s_mov_b32 s88, 0
xid_poll:
  buffer_load_dword v5, v8, s[4:7], s86 offen sc1
  s_waitcnt vmcnt(0)
  v_subrev_u32 v5, s87, v5
  v_cmp_le_u32 vcc, 64, v5
  s_add_u32 s88, s88, 1
  s_nop 1
  s_cmp_eq_u64 vcc, 0
  s_cbranch_scc1 xid_poll_ok
  s_cmp_lt_u32 s88, 400000
  s_cbranch_scc1 xid_poll
xid_poll_ok:
  v_readfirstlane_b32 s87, v5
  s_nop 3
  v_cmp_ne_u32 vcc, s87, v5
  s_nop 3
  s_cmp_eq_u64 vcc, 0
  s_cselect_b32 s87, 0, 1
  s_mov_b64 exec, -1
  v_mov_b32 v5, s87
  v_mov_b32 v6, 0x27fc0
  ds_write_b32 v6, v5
  s_waitcnt lgkmcnt(0)
qkv_Sfin:
  s_lshr_b32 s22, s13, 4
  s_lshl_b32 s24, s12, 1
  s_add_u32 s22, s22, s24
  s_and_b32 s23, s13, 15
  s_lshr_b32 s50, s3, 2
  s_lshl_b32 s51, s23, 2
  s_add_u32 s50, s50, s51
  s_lshl_b32 s50, s50, 15
  s_and_b32 s51, s3, 3
  s_lshl_b32 s51, s51, 10
  s_add_u32 s50, s50, s51
  s_add_u32 s50, s50, 0x1b00000
  s_lshr_b32 s52, s3, 2
  s_lshl_b32 s52, s52, 12
  s_add_u32 s51, s51, s52
  s_lshl_b32 s63, s22, 2
  s_and_b32 s53, s3, 3
  s_add_u32 s63, s63, s53
  s_mul_i32 s63, s63, 112
  s_lshl_b32 s53, s23, 3
  s_add_u32 s63, s63, s53
  s_lshl_b32 s63, s63, 10
  s_add_u32 s63, s63, 0x1000000
  s_and_b32 s54, s13, 7
  s_lshl_b32 s54, s54, 1
  s_and_b32 s55, s3, 1
  s_add_u32 s56, s54, s55
  s_xor_b32 s55, s55, 1
  s_add_u32 s57, s54, s55
  s_mul_i32 s55, s3, 14
  s_mul_i32 s56, s56, 112
  s_add_u32 s56, s56, s55
  s_lshl_b32 s56, s56, 10
  s_add_u32 s56, s56, 0x1d00000
  s_mul_i32 s57, s57, 112
  s_add_u32 s57, s57, s55
  s_lshl_b32 s57, s57, 10
  s_add_u32 s57, s57, 0x1d00000
  s_and_b32 s22, s3, 3
  s_lshr_b32 s23, s3, 2
  s_lshl_b32 s24, s12, 3
  s_lshl_b32 s26, s22, 1
  s_add_u32 s24, s24, s26
  s_lshl_b32 s25, s13, 16
  s_add_u32 s25, s25, s19
  s_lshl_b32 s26, s24, 10
  s_lshl_b32 s27, s13, 16
  s_add_u32 s26, s26, s27
  s_add_u32 s26, s26, 0x800000
  s_lshr_b32 s27, s22, 1
  s_and_b32 s28, s22, 1
  s_mul_i32 s29, s28, 32768
  s_mul_i32 s30, s23, 16384
  s_add_u32 s29, s29, s30
  s_lshl_b32 s30, s27, 10
  s_add_u32 s29, s29, s30
  s_add_u32 s29, s29, 0x14000
  s_mov_b32 s31, 0
  s_mul_i32 s28, s28, 0x200000
  s_lshl_b32 s30, s23, 12
  s_add_u32 s28, s28, s30
  s_lshl_b32 s30, s27, 10
  s_add_u32 s28, s28, s30
  s_add_u32 s28, s28, s25
  s_add_u32 s28, s28, 0xa00000
  s_lshl_b32 s59, s12, 13
  s_movk_i32 s61, 6144
  s_movk_i32 s62, 2048
  s_branch qkv_done
qkv_done:
  s_cmp_eq_u32 s14, 0
  s_cbranch_scc0 main_havemode
  s_barrier
  v_mov_b32 v120, 0x27fc0
  ds_read_b32 v121, v120
  s_waitcnt lgkmcnt(0)
  v_readfirstlane_b32 s18, v121
main_havemode:
  s_add_u32 s15, s15, 1
  s_add_u32 s58, s14, 1
  s_lshl_b32 s86, s12, 7
  s_add_u32 s86, s86, 0x2200400
  s_lshl_b32 s87, s13, 2
  s_add_u32 s87, s87, s86
  v_mov_b32 v120, 0
  v_mov_b32 v121, s15
  v_lshlrev_b32 v122, 2, v1
  s_barrier
  s_cmp_eq_u32 s3, 0
  s_cbranch_scc0 gb_3_not0
  s_mov_b64 exec, 1
  s_cmp_eq_u32 s18, 0
  s_cbranch_scc1 gb_3_fast
  buffer_wbl2 sc1
  s_waitcnt vmcnt(0)
  buffer_store_dword v121, v120, s[4:7], s87 offen sc1
  s_branch gb_3_sent
gb_3_fast:
  buffer_store_dword v121, v120, s[4:7], s87 offen
gb_3_sent:
  s_mov_b32 exec_lo, 0xffffffff
  s_mov_b32 exec_hi, 0
  s_mov_b32 s88, 0
gb_3_p1:
  buffer_load_dword v123, v122, s[4:7], s86 offen sc1
  s_waitcnt vmcnt(0)
  v_subrev_u32 v123, s15, v123
  v_cmp_le_u32 vcc, 64, v123
  s_add_u32 s88, s88, 1
  s_nop 1
  s_cmp_eq_u64 vcc, 0
  s_cbranch_scc1 gb_3_p1_ok
  s_cmp_lt_u32 s88, 400000
  s_cbranch_scc1 gb_3_p1
gb_3_p1_ok:
  s_cmp_eq_u32 s13, 0
  s_cbranch_scc0 gb_3_nl
  s_lshl_b32 s87, s12, 5
  v_mov_b32 v121, s58
  s_mov_b64 exec, 1
  buffer_store_dword v121, v120, s[72:75], s87 offen offset:4 sc1
gb_3_nl:
  s_cmp_eq_u32 s18, 0
  s_cbranch_scc1 gb_3_noinv
  buffer_inv sc1
  s_waitcnt vmcnt(0)
gb_3_noinv:
  s_mov_b64 exec, -1
  s_branch gb_3_join
gb_3_not0:
gb_3_join:
  s_barrier
L_att:
  s_add_u32 m0, s29, s31
  s_add_u32 s31, s31, 2048
  s_and_b32 s31, s31, 0x3fff
  s_add_u32 s60, s28, s59
  buffer_load_dwordx4 v4, s[4:7], s60 offen lds
  s_bitcmp1_b32 s59, 11
  s_cselect_b32 s60, s61, s62
  s_add_u32 s59, s59, s60
  s_and_b32 s59, s59, 0xffff
  buffer_load_dwordx4 v[8:11], v4, s[4:7], s26 offen sc1
  buffer_load_dwordx4 v[12:15], v4, s[4:7], s26 offen offset:1024 sc1
  s_add_u32 m0, s29, s31
  s_add_u32 s31, s31, 2048
  s_and_b32 s31, s31, 0x3fff
  s_add_u32 s60, s28, s59
  buffer_load_dwordx4 v4, s[4:7], s60 offen lds
  s_bitcmp1_b32 s59, 11
  s_cselect_b32 s60, s61, s62
  s_add_u32 s59, s59, s60
  s_and_b32 s59, s59, 0xffff
  s_lshl_b32 s30, s3, 9
  v_lshlrev_b32 v44, 3, v1
  v_add_u32 v44, s30, v44
  v_cmp_gt_u32 vcc, 0x400, v44
  v_add_u32 v44, 0x24000, v44
  v_mov_b32 v40, 0x3f803f80
  v_mov_b32 v41, 0x3f803f80
  v_mov_b32 v42, 0
  v_mov_b32 v43, 0
  ds_write_b64 v44, v[40:41]
  ds_write_b64 v44, v[42:43] offset:5120
  s_and_saveexec_b64 s[38:39], vcc
  ds_write_b64 v44, v[40:41] offset:4096
  ds_write_b64 v44, v[42:43] offset:9216
  s_mov_b64 exec, s[38:39]
  s_mul_i32 s30, s23, 16384
  s_add_u32 s33, s30, 0x14000
  v_add_u32 v7, s33, v4
  v_and_b32 v125, 15, v1
  v_lshlrev_b32 v125, 4, v125
  v_lshl_add_u32 v125, v3, 8, v125
  s_add_u32 s33, s30, 0x1c000
  v_add_u32 v125, s33, v125
  v_and_b32 v121, 16, v1
  v_cmp_eq_u32 vcc, 0, v121
  v_add_u32 v121, 12, v1
  v_and_b32 v121, 31, v121
  v_cmp_gt_u32 s[36:37], 8, v121
  v_mov_b32 v121, 0x24000
  v_mov_b32 v124, 0x24040
  v_cndmask_b32 v121, v121, v124, s[36:37]
  v_and_b32 v124, 27, v1
  v_cmp_eq_u32 s[38:39], 16, v124
  v_add_u32 v124, 5136, v121
  s_nop 0
  v_cndmask_b32 v121, v124, v121, s[38:39]
  v_cndmask_b32 v125, v121, v125, vcc
  v_cndmask_b32 v124, 0, 1, vcc
  v_mov_b32 v5, v7
  v_mov_b32 v6, v125
  v_add_u32 v120, 4096, v7
  s_mov_b32 s40, 4096
  v_mov_b32 v88, 0
  v_mov_b32 v104, 0
  v_mov_b32 v89, 0
  v_mov_b32 v105, 0
  v_mov_b32 v90, 0
  v_mov_b32 v106, 0
  v_mov_b32 v91, 0
  v_mov_b32 v107, 0
  v_mov_b32 v92, 0
  v_mov_b32 v108, 0
  v_mov_b32 v93, 0
  v_mov_b32 v109, 0
  v_mov_b32 v94, 0
  v_mov_b32 v110, 0
  v_mov_b32 v95, 0
  v_mov_b32 v111, 0
  v_mov_b32 v96, 0
  v_mov_b32 v112, 0
  v_mov_b32 v97, 0
  v_mov_b32 v113, 0
  v_mov_b32 v98, 0
  v_mov_b32 v114, 0
  v_mov_b32 v99, 0
  v_mov_b32 v115, 0
  v_mov_b32 v100, 0
  v_mov_b32 v116, 0
  v_mov_b32 v101, 0
  v_mov_b32 v117, 0
  v_mov_b32 v102, 0
  v_mov_b32 v118, 0
  v_mov_b32 v103, 0
  v_mov_b32 v119, 0
  v_mov_b32 v80, 0
  v_mov_b32 v24, 0
  v_mov_b32 v81, 0
  v_mov_b32 v25, 0
  v_mov_b32 v82, 0
  v_mov_b32 v26, 0
  v_mov_b32 v83, 0
  v_mov_b32 v27, 0
  v_mov_b32 v84, 0
  v_mov_b32 v28, 0
  v_mov_b32 v85, 0
  v_mov_b32 v29, 0
  v_mov_b32 v86, 0
  v_mov_b32 v30, 0
  v_mov_b32 v87, 0
  v_mov_b32 v31, 0
  s_lshl_b32 s33, s23, 2
  s_add_u32 s33, s33, 0x26800
  v_mov_b32 v0, s33
  s_xor_b32 s33, s33, 4
  v_mov_b32 v123, s33
  v_mov_b32 v72, 0
  ds_write_b32 v0, v72
  s_waitcnt vmcnt(1) lgkmcnt(0)
  s_barrier
  ds_read_b128 v[16:19], v5
  s_waitcnt lgkmcnt(0)
  v_mfma_f32_32x32x16_bf16 v[40:55], v[16:19], v[8:11], 0
  s_nop 7
  s_nop 7
  v_mfma_f32_32x32x16_bf16 v[56:71], v[16:19], v[12:15], 0
  ds_read_b128 v[20:23], v5 offset:1024
  v_exp_f32 v40, v40
  v_exp_f32 v41, v41
  v_exp_f32 v42, v42
  v_exp_f32 v43, v43
  v_mfma_f32_32x32x16_bf16 v[104:119], v[24:27], v[80:83], v[104:119]
  ds_read_b128 v[32:35], v6 offset:0
  v_exp_f32 v44, v44
  v_exp_f32 v45, v45
  v_exp_f32 v46, v46
  v_exp_f32 v47, v47
  v_mfma_f32_32x32x16_bf16 v[104:119], v[28:31], v[84:87], v[104:119]
  ds_read_b128 v[36:39], v6 offset:512
  v_exp_f32 v48, v48
  v_exp_f32 v49, v49
  v_cvt_pk_bf16_f32 v72, v40, v41
  v_exp_f32 v50, v50
  v_exp_f32 v51, v51
  v_cvt_pk_bf16_f32 v73, v42, v43
  v_exp_f32 v52, v52
  v_exp_f32 v53, v53
  v_cvt_pk_bf16_f32 v74, v44, v45
  v_exp_f32 v54, v54
  v_exp_f32 v55, v55
  v_cvt_pk_bf16_f32 v75, v46, v47
  v_cvt_pk_bf16_f32 v76, v48, v49
  v_cvt_pk_bf16_f32 v77, v50, v51
  v_cvt_pk_bf16_f32 v78, v52, v53
  v_cvt_pk_bf16_f32 v79, v54, v55
  s_waitcnt lgkmcnt(0)
  v_mfma_f32_32x32x16_bf16 v[40:55], v[20:23], v[8:11], 0
  v_exp_f32 v56, v56
  v_exp_f32 v57, v57
  v_exp_f32 v58, v58
  v_exp_f32 v59, v59
  v_mfma_f32_32x32x16_bf16 v[88:103], v[32:35], v[72:75], v[88:103]
  v_exp_f32 v60, v60
  v_exp_f32 v61, v61
  v_exp_f32 v62, v62
  v_exp_f32 v63, v63
  v_mfma_f32_32x32x16_bf16 v[88:103], v[36:39], v[76:79], v[88:103]
  v_lshlrev_b32 v122, 5, v1
  s_mov_b32 exec_lo, 0xff
  s_mov_b32 exec_hi, 0
  buffer_load_dword v121, v122, s[72:75], 0 offen offset:4 sc1
  s_mov_b64 exec, -1
  v_exp_f32 v64, v64
  v_exp_f32 v65, v65
  v_cvt_pk_bf16_f32 v80, v56, v57
  v_exp_f32 v66, v66
  v_exp_f32 v67, v67
  v_cvt_pk_bf16_f32 v81, v58, v59
  v_exp_f32 v68, v68
  v_exp_f32 v69, v69
  v_cvt_pk_bf16_f32 v82, v60, v61
  v_exp_f32 v70, v70
  v_exp_f32 v71, v71
  v_cvt_pk_bf16_f32 v83, v62, v63
  v_cvt_pk_bf16_f32 v84, v64, v65
  v_cvt_pk_bf16_f32 v85, v66, v67
  v_cvt_pk_bf16_f32 v86, v68, v69
  v_cvt_pk_bf16_f32 v87, v70, v71
  s_waitcnt vmcnt(0)
  s_mov_b32 s64, 0
  s_mov_b32 exec_lo, 0xff
  s_mov_b32 exec_hi, 0
  v_subrev_u32 v121, s58, v121
  v_cmp_le_u32 vcc, 64, v121
  s_mov_b64 exec, -1
  s_nop 3
  s_cmp_eq_u64 vcc, 0
  s_cbranch_scc0 att_ge_no
  s_cmp_eq_u32 s18, 0
  s_cbranch_scc1 inv_4
  buffer_inv sc1
  s_waitcnt vmcnt(0)
inv_4:
  s_add_u32 m0, s29, s31
  s_add_u32 s31, s31, 2048
  s_and_b32 s31, s31, 0x3fff
  s_add_u32 s60, s28, s59
  buffer_load_dwordx4 v4, s[4:7], s60 offen lds
  s_bitcmp1_b32 s59, 11
  s_cselect_b32 s60, s61, s62
  s_add_u32 s59, s59, s60
  s_and_b32 s59, s59, 0xffff
  s_add_u32 m0, s29, s31
  s_add_u32 s31, s31, 2048
  s_and_b32 s31, s31, 0x3fff
  s_add_u32 s60, s28, s59
  buffer_load_dwordx4 v4, s[4:7], s60 offen lds
  s_bitcmp1_b32 s59, 11
  s_cselect_b32 s60, s61, s62
  s_add_u32 s59, s59, s60
  s_and_b32 s59, s59, 0xffff
  s_mov_b32 s64, 1
att_ge_no:
  s_mov_b64 exec, 1
  ds_add_u32 v0, v124
  s_mov_b64 exec, -1
  s_mov_b32 s41, 4
sp_5:
  ds_read_b32 v122, v0
  s_waitcnt lgkmcnt(0)
  v_readfirstlane_b32 s42, v122
  s_nop 0
  s_cmp_ge_u32 s42, s41
  s_cbranch_scc0 sp_5
  v_mfma_f32_32x32x16_bf16 v[56:71], v[20:23], v[12:15], 0
  ds_read_b128 v[16:19], v5 offset:2048
  v_exp_f32 v40, v40
  v_exp_f32 v41, v41
  v_exp_f32 v42, v42
  v_exp_f32 v43, v43
  v_mfma_f32_32x32x16_bf16 v[104:119], v[32:35], v[80:83], v[104:119]
  ds_read_b128 v[24:27], v6 offset:1024
  v_exp_f32 v44, v44
  v_exp_f32 v45, v45
  v_exp_f32 v46, v46
  v_exp_f32 v47, v47
  v_mfma_f32_32x32x16_bf16 v[104:119], v[36:39], v[84:87], v[104:119]
  ds_read_b128 v[28:31], v6 offset:1536
  v_exp_f32 v48, v48
  v_exp_f32 v49, v49
  v_cvt_pk_bf16_f32 v72, v40, v41
  v_exp_f32 v50, v50
  v_exp_f32 v51, v51
  v_cvt_pk_bf16_f32 v73, v42, v43
  v_exp_f32 v52, v52
  v_exp_f32 v53, v53
  v_cvt_pk_bf16_f32 v74, v44, v45
  v_exp_f32 v54, v54
  v_exp_f32 v55, v55
  v_cvt_pk_bf16_f32 v75, v46, v47
  v_cvt_pk_bf16_f32 v76, v48, v49
  v_cvt_pk_bf16_f32 v77, v50, v51
  v_cvt_pk_bf16_f32 v78, v52, v53
  v_cvt_pk_bf16_f32 v79, v54, v55
  s_waitcnt lgkmcnt(0)
  v_mfma_f32_32x32x16_bf16 v[40:55], v[16:19], v[8:11], 0
  v_exp_f32 v56, v56
  v_exp_f32 v57, v57
  v_exp_f32 v58, v58
  v_exp_f32 v59, v59
  v_mfma_f32_32x32x16_bf16 v[88:103], v[24:27], v[72:75], v[88:103]
  s_cmp_eq_u32 s64, 1
  s_cbranch_scc0 att_gm_no
  s_add_u32 m0, s29, s31
  s_add_u32 s31, s31, 2048
  s_and_b32 s31, s31, 0x3fff
  s_add_u32 s60, s28, s59
  buffer_load_dwordx4 v4, s[4:7], s60 offen lds
  s_bitcmp1_b32 s59, 11
  s_cselect_b32 s60, s61, s62
  s_add_u32 s59, s59, s60
  s_and_b32 s59, s59, 0xffff
  s_add_u32 m0, s29, s31
  s_add_u32 s31, s31, 2048
  s_and_b32 s31, s31, 0x3fff
  s_add_u32 s60, s28, s59
  buffer_load_dwordx4 v4, s[4:7], s60 offen lds
  s_bitcmp1_b32 s59, 11
  s_cselect_b32 s60, s61, s62
  s_add_u32 s59, s59, s60
  s_and_b32 s59, s59, 0xffff
  s_mov_b32 s64, 2
att_gm_no:
  v_exp_f32 v60, v60
  v_exp_f32 v61, v61
  v_exp_f32 v62, v62
  v_exp_f32 v63, v63
  v_mfma_f32_32x32x16_bf16 v[88:103], v[28:31], v[76:79], v[88:103]
  v_exp_f32 v64, v64
  v_exp_f32 v65, v65
  v_cvt_pk_bf16_f32 v80, v56, v57
  v_exp_f32 v66, v66
  v_exp_f32 v67, v67
  v_cvt_pk_bf16_f32 v81, v58, v59
  v_exp_f32 v68, v68
  v_exp_f32 v69, v69
  v_cvt_pk_bf16_f32 v82, v60, v61
  v_exp_f32 v70, v70
  v_exp_f32 v71, v71
  v_cvt_pk_bf16_f32 v83, v62, v63
  v_cvt_pk_bf16_f32 v84, v64, v65
  v_cvt_pk_bf16_f32 v85, v66, v67
  v_cvt_pk_bf16_f32 v86, v68, v69
  v_cvt_pk_bf16_f32 v87, v70, v71
  s_cmp_lg_u32 s64, 0
  s_cbranch_scc1 att_gl_no
  v_lshlrev_b32 v122, 5, v1
  s_mov_b32 s86, 4
  s_mov_b32 exec_lo, 0xff
  s_mov_b32 exec_hi, 0
  s_mov_b32 s88, 0
att_gl:
  buffer_load_dword v121, v122, s[72:75], s86 offen sc1
  s_waitcnt vmcnt(0)
  v_subrev_u32 v121, s58, v121
  v_cmp_le_u32 vcc, 64, v121
  s_add_u32 s88, s88, 1
  s_nop 1
  s_cmp_eq_u64 vcc, 0
  s_cbranch_scc1 att_gl_ok
  s_cmp_lt_u32 s88, 400000
  s_cbranch_scc1 att_gl
att_gl_ok:
  s_mov_b64 exec, -1
  s_cmp_eq_u32 s18, 0
  s_cbranch_scc1 inv_6
  buffer_inv sc1
  s_waitcnt vmcnt(0)
inv_6:
  s_add_u32 m0, s29, s31
  s_add_u32 s31, s31, 2048
  s_and_b32 s31, s31, 0x3fff
  s_add_u32 s60, s28, s59
  buffer_load_dwordx4 v4, s[4:7], s60 offen lds
  s_bitcmp1_b32 s59, 11
  s_cselect_b32 s60, s61, s62
  s_add_u32 s59, s59, s60
  s_and_b32 s59, s59, 0xffff
  s_add_u32 m0, s29, s31
  s_add_u32 s31, s31, 2048
  s_and_b32 s31, s31, 0x3fff
  s_add_u32 s60, s28, s59
  buffer_load_dwordx4 v4, s[4:7], s60 offen lds
  s_bitcmp1_b32 s59, 11
  s_cselect_b32 s60, s61, s62
  s_add_u32 s59, s59, s60
  s_and_b32 s59, s59, 0xffff
  s_add_u32 m0, s29, s31
  s_add_u32 s31, s31, 2048
  s_and_b32 s31, s31, 0x3fff
  s_add_u32 s60, s28, s59
  buffer_load_dwordx4 v4, s[4:7], s60 offen lds
  s_bitcmp1_b32 s59, 11
  s_cselect_b32 s60, s61, s62
  s_add_u32 s59, s59, s60
  s_and_b32 s59, s59, 0xffff
  s_add_u32 m0, s29, s31
  s_add_u32 s31, s31, 2048
  s_and_b32 s31, s31, 0x3fff
  s_add_u32 s60, s28, s59
  buffer_load_dwordx4 v4, s[4:7], s60 offen lds
  s_bitcmp1_b32 s59, 11
  s_cselect_b32 s60, s61, s62
  s_add_u32 s59, s59, s60
  s_and_b32 s59, s59, 0xffff
att_gl_no:
  v_mfma_f32_32x32x16_bf16 v[56:71], v[16:19], v[12:15], 0
  ds_read_b128 v[20:23], v5 offset:3072
  v_exp_f32 v40, v40
  v_exp_f32 v41, v41
  v_exp_f32 v42, v42
  v_exp_f32 v43, v43
  v_mfma_f32_32x32x16_bf16 v[104:119], v[24:27], v[80:83], v[104:119]
  ds_read_b128 v[32:35], v6 offset:2048
  v_exp_f32 v44, v44
  v_exp_f32 v45, v45
  v_exp_f32 v46, v46
  v_exp_f32 v47, v47
  v_mfma_f32_32x32x16_bf16 v[104:119], v[28:31], v[84:87], v[104:119]
  ds_read_b128 v[36:39], v6 offset:2560
  v_exp_f32 v48, v48
  v_exp_f32 v49, v49
  v_cvt_pk_bf16_f32 v72, v40, v41
  v_exp_f32 v50, v50
  v_exp_f32 v51, v51
  v_cvt_pk_bf16_f32 v73, v42, v43
  v_exp_f32 v52, v52
  v_exp_f32 v53, v53
  v_cvt_pk_bf16_f32 v74, v44, v45
  v_exp_f32 v54, v54
  v_exp_f32 v55, v55
  v_cvt_pk_bf16_f32 v75, v46, v47
  v_cvt_pk_bf16_f32 v76, v48, v49
  v_cvt_pk_bf16_f32 v77, v50, v51
  v_cvt_pk_bf16_f32 v78, v52, v53
  v_cvt_pk_bf16_f32 v79, v54, v55
  s_waitcnt lgkmcnt(0)
  v_mfma_f32_32x32x16_bf16 v[40:55], v[20:23], v[8:11], 0
  v_exp_f32 v56, v56
  v_exp_f32 v57, v57
  v_exp_f32 v58, v58
  v_exp_f32 v59, v59
  v_mfma_f32_32x32x16_bf16 v[88:103], v[32:35], v[72:75], v[88:103]
  v_exp_f32 v60, v60
  v_exp_f32 v61, v61
  v_exp_f32 v62, v62
  v_exp_f32 v63, v63
  v_mfma_f32_32x32x16_bf16 v[88:103], v[36:39], v[76:79], v[88:103]
  v_exp_f32 v64, v64
  v_exp_f32 v65, v65
  v_cvt_pk_bf16_f32 v80, v56, v57
  v_exp_f32 v66, v66
  v_exp_f32 v67, v67
  v_cvt_pk_bf16_f32 v81, v58, v59
  v_exp_f32 v68, v68
  v_exp_f32 v69, v69
  v_cvt_pk_bf16_f32 v82, v60, v61
  v_exp_f32 v70, v70
  v_exp_f32 v71, v71
  v_cvt_pk_bf16_f32 v83, v62, v63
  v_cvt_pk_bf16_f32 v84, v64, v65
  v_cvt_pk_bf16_f32 v85, v66, v67
  v_cvt_pk_bf16_f32 v86, v68, v69
  v_cvt_pk_bf16_f32 v87, v70, v71
  s_waitcnt vmcnt(1)
  s_mov_b64 exec, 1
  ds_add_u32 v0, v124
  s_mov_b64 exec, -1
  s_mov_b32 s41, 8
sp_7:
  ds_read_b32 v122, v0
  s_waitcnt lgkmcnt(0)
  v_readfirstlane_b32 s42, v122
  s_nop 0
  s_cmp_ge_u32 s42, s41
  s_cbranch_scc0 sp_7
  v_mfma_f32_32x32x16_bf16 v[56:71], v[20:23], v[12:15], 0
  ds_read_b128 v[16:19], v120
  v_exp_f32 v40, v40
  v_exp_f32 v41, v41
  v_exp_f32 v42, v42
  v_exp_f32 v43, v43
  v_mfma_f32_32x32x16_bf16 v[104:119], v[32:35], v[80:83], v[104:119]
  ds_read_b128 v[24:27], v6 offset:3072
  v_exp_f32 v44, v44
  v_exp_f32 v45, v45
  v_exp_f32 v46, v46
  v_exp_f32 v47, v47
  v_mfma_f32_32x32x16_bf16 v[104:119], v[36:39], v[84:87], v[104:119]
  ds_read_b128 v[28:31], v6 offset:3584
  v_exp_f32 v48, v48
  v_exp_f32 v49, v49
  v_cvt_pk_bf16_f32 v72, v40, v41
  v_exp_f32 v50, v50
  v_exp_f32 v51, v51
  v_cvt_pk_bf16_f32 v73, v42, v43
  v_exp_f32 v52, v52
  v_exp_f32 v53, v53
  v_cvt_pk_bf16_f32 v74, v44, v45
  v_exp_f32 v54, v54
  v_exp_f32 v55, v55
  v_cvt_pk_bf16_f32 v75, v46, v47
  v_cvt_pk_bf16_f32 v76, v48, v49
  v_cvt_pk_bf16_f32 v77, v50, v51
  v_cvt_pk_bf16_f32 v78, v52, v53
  v_cvt_pk_bf16_f32 v79, v54, v55
  s_waitcnt lgkmcnt(0)
  v_mfma_f32_32x32x16_bf16 v[40:55], v[16:19], v[8:11], 0
  v_mov_b32 v5, v120
  v_mad_u32_u24 v6, v124, s40, v125
  s_add_u32 s40, s40, 4096
  s_and_b32 s40, s40, 0x3fff
  v_add_u32 v120, s40, v7
  v_exp_f32 v56, v56
  v_exp_f32 v57, v57
  v_exp_f32 v58, v58
  v_exp_f32 v59, v59
  v_mfma_f32_32x32x16_bf16 v[88:103], v[24:27], v[72:75], v[88:103]
  s_add_u32 m0, s29, s31
  s_add_u32 s31, s31, 2048
  s_and_b32 s31, s31, 0x3fff
  s_add_u32 s60, s28, s59
  buffer_load_dwordx4 v4, s[4:7], s60 offen lds
  s_bitcmp1_b32 s59, 11
  s_cselect_b32 s60, s61, s62
  s_add_u32 s59, s59, s60
  s_and_b32 s59, s59, 0xffff
  v_exp_f32 v60, v60
  v_exp_f32 v61, v61
  v_exp_f32 v62, v62
  v_exp_f32 v63, v63
  v_mfma_f32_32x32x16_bf16 v[88:103], v[28:31], v[76:79], v[88:103]
  s_add_u32 m0, s29, s31
  s_add_u32 s31, s31, 2048
  s_and_b32 s31, s31, 0x3fff
  s_add_u32 s60, s28, s59
  buffer_load_dwordx4 v4, s[4:7], s60 offen lds
  s_bitcmp1_b32 s59, 11
  s_cselect_b32 s60, s61, s62
  s_add_u32 s59, s59, s60
  s_and_b32 s59, s59, 0xffff
  v_exp_f32 v64, v64
  v_exp_f32 v65, v65
  v_cvt_pk_bf16_f32 v80, v56, v57
  v_exp_f32 v66, v66
  v_exp_f32 v67, v67
  v_cvt_pk_bf16_f32 v81, v58, v59
  v_exp_f32 v68, v68
  v_exp_f32 v69, v69
  v_cvt_pk_bf16_f32 v82, v60, v61
  v_exp_f32 v70, v70
  v_exp_f32 v71, v71
  v_cvt_pk_bf16_f32 v83, v62, v63
  v_cvt_pk_bf16_f32 v84, v64, v65
  v_cvt_pk_bf16_f32 v85, v66, v67
  v_cvt_pk_bf16_f32 v86, v68, v69
  v_cvt_pk_bf16_f32 v87, v70, v71
  s_mov_b32 s32, 1
  s_mov_b32 s66, 0
  s_mov_b32 s67, 0
.p2align 6
att_loop:
  v_mfma_f32_32x32x16_bf16 v[56:71], v[16:19], v[12:15], 0
  ds_read_b128 v[20:23], v5 offset:1024
  v_exp_f32 v40, v40
  v_exp_f32 v41, v41
  v_exp_f32 v42, v42
  v_exp_f32 v43, v43
  v_mfma_f32_32x32x16_bf16 v[104:119], v[24:27], v[80:83], v[104:119]
  ds_read_b128 v[32:35], v6 offset:0
  v_exp_f32 v44, v44
  v_exp_f32 v45, v45
  v_exp_f32 v46, v46
  v_exp_f32 v47, v47
  v_mfma_f32_32x32x16_bf16 v[104:119], v[28:31], v[84:87], v[104:119]
  ds_read_b128 v[36:39], v6 offset:512
  s_cmp_lg_u32 s14, 0
  s_cbranch_scc1 w2_8_x
  s_cmp_gt_u32 s32, 4
  s_cbranch_scc1 tr_9
  s_cmp_gt_u32 s32, 2
  s_cbranch_scc1 tr_10
  s_cmp_gt_u32 s32, 1
  s_cbranch_scc1 tr_11
  buffer_load_dwordx4 a[0:3], v4, s[4:7], s56 offen offset:0
  buffer_load_dwordx4 a[4:7], v4, s[4:7], s57 offen offset:0
  s_branch w2_8_x
tr_11:
  buffer_load_dwordx4 a[16:19], v4, s[4:7], s56 offen offset:2048
  buffer_load_dwordx4 a[20:23], v4, s[4:7], s57 offen offset:2048
  s_branch w2_8_x
tr_10:
  s_cmp_gt_u32 s32, 3
  s_cbranch_scc1 tr_12
  buffer_load_dwordx4 a[32:35], v4, s[4:7], s56 offen offset:0
  buffer_load_dwordx4 a[36:39], v4, s[4:7], s57 offen offset:0
  s_branch w2_8_x
tr_12:
  buffer_load_dwordx4 a[48:51], v4, s[4:7], s56 offen offset:2048
  buffer_load_dwordx4 a[52:55], v4, s[4:7], s57 offen offset:2048
  s_branch w2_8_x
tr_9:
  s_cmp_gt_u32 s32, 6
  s_cbranch_scc1 tr_13
  s_cmp_gt_u32 s32, 5
  s_cbranch_scc1 tr_14
  buffer_load_dwordx4 a[64:67], v4, s[4:7], s56 offen offset:0
  buffer_load_dwordx4 a[68:71], v4, s[4:7], s57 offen offset:0
  s_branch w2_8_x
tr_14:
  buffer_load_dwordx4 a[80:83], v4, s[4:7], s56 offen offset:2048
  buffer_load_dwordx4 a[84:87], v4, s[4:7], s57 offen offset:2048
  s_branch w2_8_x
tr_13:
  buffer_load_dwordx4 a[96:99], v4, s[4:7], s56 offen offset:0
  buffer_load_dwordx4 a[100:103], v4, s[4:7], s57 offen offset:0
  s_branch w2_8_x
w2_8_x:
  v_exp_f32 v48, v48
  v_exp_f32 v49, v49
  v_cvt_pk_bf16_f32 v72, v40, v41
  v_exp_f32 v50, v50
  v_exp_f32 v51, v51
  v_cvt_pk_bf16_f32 v73, v42, v43
  v_exp_f32 v52, v52
  v_exp_f32 v53, v53
  v_cvt_pk_bf16_f32 v74, v44, v45
  v_exp_f32 v54, v54
  v_exp_f32 v55, v55
  v_cvt_pk_bf16_f32 v75, v46, v47
  v_cvt_pk_bf16_f32 v76, v48, v49
  v_cvt_pk_bf16_f32 v77, v50, v51
  v_cvt_pk_bf16_f32 v78, v52, v53
  v_cvt_pk_bf16_f32 v79, v54, v55
  s_waitcnt lgkmcnt(0)
  v_mfma_f32_32x32x16_bf16 v[40:55], v[20:23], v[8:11], 0
  s_cmp_eq_u32 s32, 7
  s_cbranch_scc1 hp_15_x
  s_cmp_lg_u32 s14, 0
  s_cbranch_scc1 hp_15_1
  s_waitcnt vmcnt(3)
  s_branch hp_15_p
hp_15_1:
  s_waitcnt vmcnt(1)
hp_15_p:
  s_mov_b64 exec, 1
  ds_add_u32 v0, v124
  s_mov_b64 exec, -1
hp_15_x:
  v_exp_f32 v56, v56
  v_exp_f32 v57, v57
  v_exp_f32 v58, v58
  v_exp_f32 v59, v59
  v_mfma_f32_32x32x16_bf16 v[88:103], v[32:35], v[72:75], v[88:103]
  s_cmp_ge_u32 s32, 6
  s_cbranch_scc1 w1_16_pf
  s_add_u32 m0, s51, s66
  s_add_u32 s66, s66, 8192
  s_add_u32 s34, s50, s67
  buffer_load_dwordx4 v4, s[4:7], s34 offen lds
  s_branch w1_16_x
w1_16_pf:
  s_cmp_eq_u32 s32, 6
  s_cbranch_scc0 w1_16_x
  v_min_u32 v122, 47, v1
  v_lshlrev_b32 v122, 7, v122
  s_and_b32 s34, s3, 3
  s_lshl_b32 s34, s34, 10
  s_sub_u32 s34, s50, s34
  s_lshr_b32 s35, s3, 2
  s_lshl_b32 s35, s35, 15
  s_sub_u32 s34, s34, s35
  s_lshr_b32 s35, s3, 1
  s_lshl_b32 s35, s35, 15
  s_add_u32 s34, s34, s35
  s_and_b32 s35, s3, 1
  s_mul_i32 s35, s35, 6144
  s_add_u32 s34, s34, s35
  s_add_u32 s34, s34, 0x5000
  buffer_load_dword v126, v122, s[4:7], s34 offen
w1_16_x:
  v_exp_f32 v60, v60
  v_exp_f32 v61, v61
  v_exp_f32 v62, v62
  v_exp_f32 v63, v63
  v_mfma_f32_32x32x16_bf16 v[88:103], v[36:39], v[76:79], v[88:103]
  v_exp_f32 v64, v64
  v_exp_f32 v65, v65
  v_cvt_pk_bf16_f32 v80, v56, v57
  v_exp_f32 v66, v66
  v_exp_f32 v67, v67
  v_cvt_pk_bf16_f32 v81, v58, v59
  v_exp_f32 v68, v68
  v_exp_f32 v69, v69
  v_cvt_pk_bf16_f32 v82, v60, v61
  v_exp_f32 v70, v70
  v_exp_f32 v71, v71
  v_cvt_pk_bf16_f32 v83, v62, v63
  v_cvt_pk_bf16_f32 v84, v64, v65
  v_cvt_pk_bf16_f32 v85, v66, v67
  v_cvt_pk_bf16_f32 v86, v68, v69
  v_cvt_pk_bf16_f32 v87, v70, v71
  v_mfma_f32_32x32x16_bf16 v[56:71], v[20:23], v[12:15], 0
  ds_read_b128 v[16:19], v5 offset:2048
  v_exp_f32 v40, v40
  v_exp_f32 v41, v41
  v_exp_f32 v42, v42
  v_exp_f32 v43, v43
  v_mfma_f32_32x32x16_bf16 v[104:119], v[32:35], v[80:83], v[104:119]
  ds_read_b128 v[24:27], v6 offset:1024
  v_exp_f32 v44, v44
  v_exp_f32 v45, v45
  v_exp_f32 v46, v46
  v_exp_f32 v47, v47
  v_mfma_f32_32x32x16_bf16 v[104:119], v[36:39], v[84:87], v[104:119]
  ds_read_b128 v[28:31], v6 offset:1536
  v_exp_f32 v48, v48
  v_exp_f32 v49, v49
  v_cvt_pk_bf16_f32 v72, v40, v41
  v_exp_f32 v50, v50
  v_exp_f32 v51, v51
  v_cvt_pk_bf16_f32 v73, v42, v43
  v_exp_f32 v52, v52
  v_exp_f32 v53, v53
  v_cvt_pk_bf16_f32 v74, v44, v45
  v_exp_f32 v54, v54
  v_exp_f32 v55, v55
  v_cvt_pk_bf16_f32 v75, v46, v47
  v_cvt_pk_bf16_f32 v76, v48, v49
  v_cvt_pk_bf16_f32 v77, v50, v51
  v_cvt_pk_bf16_f32 v78, v52, v53
  v_cvt_pk_bf16_f32 v79, v54, v55
  s_waitcnt lgkmcnt(0)
  v_mfma_f32_32x32x16_bf16 v[40:55], v[16:19], v[8:11], 0
  v_exp_f32 v56, v56
  v_exp_f32 v57, v57
  v_exp_f32 v58, v58
  v_exp_f32 v59, v59
  v_mfma_f32_32x32x16_bf16 v[88:103], v[24:27], v[72:75], v[88:103]
  s_cmp_ge_u32 s32, 6
  s_cbranch_scc1 w1_17_pf
  s_add_u32 m0, s51, s66
  s_add_u32 s66, s66, 8192
  s_add_u32 s34, s50, s67
  s_add_u32 s34, s34, 0x10000
  s_add_u32 s67, s67, 4096
  buffer_load_dwordx4 v4, s[4:7], s34 offen lds
  s_branch w1_17_x
w1_17_pf:
w1_17_x:
  v_exp_f32 v60, v60
  v_exp_f32 v61, v61
  v_exp_f32 v62, v62
  v_exp_f32 v63, v63
  v_mfma_f32_32x32x16_bf16 v[88:103], v[28:31], v[76:79], v[88:103]
  ds_read_b32 v122, v0
  ds_read_b32 v121, v123
  v_exp_f32 v64, v64
  v_exp_f32 v65, v65
  v_cvt_pk_bf16_f32 v80, v56, v57
  v_exp_f32 v66, v66
  v_exp_f32 v67, v67
  v_cvt_pk_bf16_f32 v81, v58, v59
  v_exp_f32 v68, v68
  v_exp_f32 v69, v69
  v_cvt_pk_bf16_f32 v82, v60, v61
  v_exp_f32 v70, v70
  v_exp_f32 v71, v71
  v_cvt_pk_bf16_f32 v83, v62, v63
  v_cvt_pk_bf16_f32 v84, v64, v65
  v_cvt_pk_bf16_f32 v85, v66, v67
  v_cvt_pk_bf16_f32 v86, v68, v69
  v_cvt_pk_bf16_f32 v87, v70, v71
  v_mfma_f32_32x32x16_bf16 v[56:71], v[16:19], v[12:15], 0
  ds_read_b128 v[20:23], v5 offset:3072
  v_exp_f32 v40, v40
  v_exp_f32 v41, v41
  v_exp_f32 v42, v42
  v_exp_f32 v43, v43
  v_mfma_f32_32x32x16_bf16 v[104:119], v[24:27], v[80:83], v[104:119]
  ds_read_b128 v[32:35], v6 offset:2048
  v_exp_f32 v44, v44
  v_exp_f32 v45, v45
  v_exp_f32 v46, v46
  v_exp_f32 v47, v47
  v_mfma_f32_32x32x16_bf16 v[104:119], v[28:31], v[84:87], v[104:119]
  ds_read_b128 v[36:39], v6 offset:2560
  s_cmp_lg_u32 s14, 0
  s_cbranch_scc1 w2_18_x
  s_cmp_gt_u32 s32, 4
  s_cbranch_scc1 tr_19
  s_cmp_gt_u32 s32, 2
  s_cbranch_scc1 tr_20
  s_cmp_gt_u32 s32, 1
  s_cbranch_scc1 tr_21
  buffer_load_dwordx4 a[8:11], v4, s[4:7], s56 offen offset:1024
  buffer_load_dwordx4 a[12:15], v4, s[4:7], s57 offen offset:1024
  s_branch w2_18_x
tr_21:
  buffer_load_dwordx4 a[24:27], v4, s[4:7], s56 offen offset:3072
  buffer_load_dwordx4 a[28:31], v4, s[4:7], s57 offen offset:3072
  s_add_u32 s56, s56, 4096
  s_add_u32 s57, s57, 4096
  s_branch w2_18_x
tr_20:
  s_cmp_gt_u32 s32, 3
  s_cbranch_scc1 tr_22
  buffer_load_dwordx4 a[40:43], v4, s[4:7], s56 offen offset:1024
  buffer_load_dwordx4 a[44:47], v4, s[4:7], s57 offen offset:1024
  s_branch w2_18_x
tr_22:
  buffer_load_dwordx4 a[56:59], v4, s[4:7], s56 offen offset:3072
  buffer_load_dwordx4 a[60:63], v4, s[4:7], s57 offen offset:3072
  s_add_u32 s56, s56, 4096
  s_add_u32 s57, s57, 4096
  s_branch w2_18_x
tr_19:
  s_cmp_gt_u32 s32, 6
  s_cbranch_scc1 tr_23
  s_cmp_gt_u32 s32, 5
  s_cbranch_scc1 tr_24
  buffer_load_dwordx4 a[72:75], v4, s[4:7], s56 offen offset:1024
  buffer_load_dwordx4 a[76:79], v4, s[4:7], s57 offen offset:1024
  s_branch w2_18_x
tr_24:
  buffer_load_dwordx4 a[88:91], v4, s[4:7], s56 offen offset:3072
  buffer_load_dwordx4 a[92:95], v4, s[4:7], s57 offen offset:3072
  s_add_u32 s56, s56, 4096
  s_add_u32 s57, s57, 4096
  s_branch w2_18_x
tr_23:
  s_branch w2_18_x
w2_18_x:
  v_exp_f32 v48, v48
  v_exp_f32 v49, v49
  v_cvt_pk_bf16_f32 v72, v40, v41
  v_exp_f32 v50, v50
  v_exp_f32 v51, v51
  v_cvt_pk_bf16_f32 v73, v42, v43
  v_exp_f32 v52, v52
  v_exp_f32 v53, v53
  v_cvt_pk_bf16_f32 v74, v44, v45
  v_exp_f32 v54, v54
  v_exp_f32 v55, v55
  v_cvt_pk_bf16_f32 v75, v46, v47
  v_cvt_pk_bf16_f32 v76, v48, v49
  v_cvt_pk_bf16_f32 v77, v50, v51
  v_cvt_pk_bf16_f32 v78, v52, v53
  v_cvt_pk_bf16_f32 v79, v54, v55
  s_waitcnt lgkmcnt(0)
  v_mfma_f32_32x32x16_bf16 v[40:55], v[20:23], v[8:11], 0
  s_cmp_eq_u32 s32, 7
  s_cbranch_scc1 hc_25_x
  v_readfirstlane_b32 s42, v122
  v_readfirstlane_b32 s43, v121
  s_lshl_b32 s41, s32, 2
  s_add_u32 s41, s41, 8
  s_cmp_ge_u32 s42, s41
  s_cbranch_scc1 hc_25_ok
sp_26:
  ds_read_b32 v122, v0
  s_waitcnt lgkmcnt(0)
  v_readfirstlane_b32 s42, v122
  s_nop 0
  s_cmp_ge_u32 s42, s41
  s_cbranch_scc0 sp_26
hc_25_ok:
  s_cmp_ge_u32 s43, s41
  s_cbranch_scc1 hc_25_hi
  s_setprio 0
  s_branch hc_25_x
hc_25_hi:
  s_setprio 1
hc_25_x:
  v_exp_f32 v56, v56
  v_exp_f32 v57, v57
  v_exp_f32 v58, v58
  v_exp_f32 v59, v59
  v_mfma_f32_32x32x16_bf16 v[88:103], v[32:35], v[72:75], v[88:103]
  s_cmp_ge_u32 s32, 5
  s_cbranch_scc1 hda_27
  s_add_u32 m0, s29, s31
  s_add_u32 s31, s31, 2048
  s_and_b32 s31, s31, 0x3fff
  s_add_u32 s60, s28, s59
  buffer_load_dwordx4 v4, s[4:7], s60 offen lds
  s_bitcmp1_b32 s59, 11
  s_cselect_b32 s60, s61, s62
  s_add_u32 s59, s59, s60
  s_and_b32 s59, s59, 0xffff
hda_27:
  v_exp_f32 v60, v60
  v_exp_f32 v61, v61
  v_exp_f32 v62, v62
  v_exp_f32 v63, v63
  v_mfma_f32_32x32x16_bf16 v[88:103], v[36:39], v[76:79], v[88:103]
  v_exp_f32 v64, v64
  v_exp_f32 v65, v65
  v_cvt_pk_bf16_f32 v80, v56, v57
  v_exp_f32 v66, v66
  v_exp_f32 v67, v67
  v_cvt_pk_bf16_f32 v81, v58, v59
  v_exp_f32 v68, v68
  v_exp_f32 v69, v69
  v_cvt_pk_bf16_f32 v82, v60, v61
  v_exp_f32 v70, v70
  v_exp_f32 v71, v71
  v_cvt_pk_bf16_f32 v83, v62, v63
  v_cvt_pk_bf16_f32 v84, v64, v65
  v_cvt_pk_bf16_f32 v85, v66, v67
  v_cvt_pk_bf16_f32 v86, v68, v69
  v_cvt_pk_bf16_f32 v87, v70, v71
  v_mfma_f32_32x32x16_bf16 v[56:71], v[20:23], v[12:15], 0
  ds_read_b128 v[16:19], v120
  v_exp_f32 v40, v40
  v_exp_f32 v41, v41
  v_exp_f32 v42, v42
  v_exp_f32 v43, v43
  v_mfma_f32_32x32x16_bf16 v[104:119], v[32:35], v[80:83], v[104:119]
  ds_read_b128 v[24:27], v6 offset:3072
  v_exp_f32 v44, v44
  v_exp_f32 v45, v45
  v_exp_f32 v46, v46
  v_exp_f32 v47, v47
  v_mfma_f32_32x32x16_bf16 v[104:119], v[36:39], v[84:87], v[104:119]
  ds_read_b128 v[28:31], v6 offset:3584
  s_cmp_ge_u32 s32, 5
  s_cbranch_scc1 hda_28
  s_add_u32 m0, s29, s31
  s_add_u32 s31, s31, 2048
  s_and_b32 s31, s31, 0x3fff
  s_add_u32 s60, s28, s59
  buffer_load_dwordx4 v4, s[4:7], s60 offen lds
  s_bitcmp1_b32 s59, 11
  s_cselect_b32 s60, s61, s62
  s_add_u32 s59, s59, s60
  s_and_b32 s59, s59, 0xffff
hda_28:
  v_exp_f32 v48, v48
  v_exp_f32 v49, v49
  v_cvt_pk_bf16_f32 v72, v40, v41
  v_exp_f32 v50, v50
  v_exp_f32 v51, v51
  v_cvt_pk_bf16_f32 v73, v42, v43
  v_exp_f32 v52, v52
  v_exp_f32 v53, v53
  v_cvt_pk_bf16_f32 v74, v44, v45
  v_exp_f32 v54, v54
  v_exp_f32 v55, v55
  v_cvt_pk_bf16_f32 v75, v46, v47
  v_cvt_pk_bf16_f32 v76, v48, v49
  v_cvt_pk_bf16_f32 v77, v50, v51
  v_cvt_pk_bf16_f32 v78, v52, v53
  v_cvt_pk_bf16_f32 v79, v54, v55
  s_waitcnt lgkmcnt(0)
  v_mfma_f32_32x32x16_bf16 v[40:55], v[16:19], v[8:11], 0
  v_mov_b32 v5, v120
  v_mad_u32_u24 v6, v124, s40, v125
  s_add_u32 s40, s40, 4096
  s_and_b32 s40, s40, 0x3fff
  v_add_u32 v120, s40, v7
  v_exp_f32 v56, v56
  v_exp_f32 v57, v57
  v_exp_f32 v58, v58
  v_exp_f32 v59, v59
  v_mfma_f32_32x32x16_bf16 v[88:103], v[24:27], v[72:75], v[88:103]
  s_cmp_eq_u32 s32, 6
  s_cbranch_scc0 tc_29
  v_lshlrev_b32 v122, 7, v1
  s_mul_i32 s34, s13, 16384
  s_and_b32 s35, s3, 1
  s_lshl_b32 s35, s35, 13
  s_add_u32 s34, s34, s35
  s_add_u32 s34, s34, 0x1a00000
  s_cmp_lt_u32 s3, 4
  s_cselect_b32 s34, s63, s34
  s_cmp_ge_u32 s3, 6
  s_cbranch_scc1 tc_29_o
  buffer_load_dword v126, v122, s[4:7], s34 offen
tc_29_o:
  s_lshl_b32 s34, s24, 5
  s_add_u32 s34, s34, s13
  s_lshl_b32 s34, s34, 10
  s_add_u32 s34, s34, 0xe00000
  v_and_b32 v122, 7, v1
  v_lshlrev_b32 v122, 7, v122
  v_and_b32 v121, 8, v1
  v_lshl_add_u32 v122, v121, 12, v122
  buffer_load_dword v126, v122, s[4:7], s34 offen
tc_29:
  v_exp_f32 v60, v60
  v_exp_f32 v61, v61
  v_exp_f32 v62, v62
  v_exp_f32 v63, v63
  v_mfma_f32_32x32x16_bf16 v[88:103], v[28:31], v[76:79], v[88:103]
  v_exp_f32 v64, v64
  v_exp_f32 v65, v65
  v_cvt_pk_bf16_f32 v80, v56, v57
  v_exp_f32 v66, v66
  v_exp_f32 v67, v67
  v_cvt_pk_bf16_f32 v81, v58, v59
  v_exp_f32 v68, v68
  v_exp_f32 v69, v69
  v_cvt_pk_bf16_f32 v82, v60, v61
  v_exp_f32 v70, v70
  v_exp_f32 v71, v71
  v_cvt_pk_bf16_f32 v83, v62, v63
  v_cvt_pk_bf16_f32 v84, v64, v65
  v_cvt_pk_bf16_f32 v85, v66, v67
  v_cvt_pk_bf16_f32 v86, v68, v69
  v_cvt_pk_bf16_f32 v87, v70, v71
  s_add_u32 s32, s32, 1
  s_cmp_lt_u32 s32, 8
  s_cbranch_scc1 att_loop
  s_setprio 0
  v_mfma_f32_32x32x16_bf16 v[104:119], v[24:27], v[80:83], v[104:119]
  v_mfma_f32_32x32x16_bf16 v[104:119], v[28:31], v[84:87], v[104:119]
  s_mul_i32 s34, s23, 16384
  s_xor_b32 s38, s23, 1
  s_mul_i32 s38, s38, 16384
  s_lshl_b32 s39, s22, 11
  s_add_u32 s39, s39, 0x14000
  s_add_u32 s33, s39, s34
  s_add_u32 s35, s39, s38
  s_lshl_b32 s39, s22, 8
  s_add_u32 s39, s39, 0x1c000
  s_add_u32 s36, s39, s34
  s_add_u32 s37, s39, s38
  v_add_u32 v5, s33, v4
  v_add_u32 v6, s35, v4
  v_lshlrev_b32 v121, 2, v1
  v_add_u32 v120, s36, v121
  v_add_u32 v121, s37, v121
  s_cmp_eq_u32 s23, 0
  s_cbranch_scc1 att_x0
  ds_write_b128 v5, v[88:91]
  ds_write_b128 v5, v[92:95] offset:1024
  ds_write_b32 v120, v96
  s_nop 7
  s_nop 7
  v_mov_b32 v88, v104
  v_mov_b32 v89, v105
  v_mov_b32 v90, v106
  v_mov_b32 v91, v107
  v_mov_b32 v92, v108
  v_mov_b32 v93, v109
  v_mov_b32 v94, v110
  v_mov_b32 v95, v111
  v_mov_b32 v96, v112
  s_add_u32 s24, s24, 1
  v_mov_b32 v8, v12
  v_mov_b32 v9, v13
  v_mov_b32 v10, v14
  v_mov_b32 v11, v15
  s_branch att_x1
att_x0:
  s_nop 7
  s_nop 7
  s_nop 3
  ds_write_b128 v5, v[104:107]
  ds_write_b128 v5, v[108:111] offset:1024
  ds_write_b32 v120, v112
att_x1:
  s_lshl_b32 s65, s24, 5
  s_add_u32 s65, s65, s13
  s_lshl_b32 s65, s65, 10
  s_add_u32 s65, s65, 0xe00000
  s_lshl_b32 s22, s12, 2
  s_lshr_b32 s26, s13, 3
  s_add_u32 s22, s22, s26
  s_and_b32 s23, s13, 7
  s_lshr_b32 s26, s3, 1
  s_and_b32 s26, s26, 1
  s_and_b32 s27, s3, 1
  s_lshl_b32 s28, s22, 1
  s_lshl_b32 s29, s23, 1
  s_add_u32 s30, s28, s26
  s_xor_b32 s26, s26, 1
  s_add_u32 s31, s28, s26
  s_add_u32 s33, s29, s27
  s_xor_b32 s27, s27, 1
  s_add_u32 s34, s29, s27
  s_lshl_b32 s40, s30, 5
  s_lshl_b32 s41, s33, 1
  s_add_u32 s40, s40, s41
  s_lshl_b32 s41, s40, 10
  s_mov_b32 s44, s41
  s_mov_b32 s42, 0x2000000
  s_lshl_b32 s43, s30, 12
  s_add_u32 s42, s42, s43
  s_lshl_b32 s43, s33, 3
  s_add_u32 s42, s42, s43
  s_and_b32 s35, s3, 3
  s_mul_i32 s35, s35, 8
  s_mul_i32 s36, s30, 32
  s_add_u32 s36, s36, s35
  s_lshl_b32 s36, s36, 10
  s_add_u32 s36, s36, 0xe00000
  s_mul_i32 s37, s31, 32
  s_add_u32 s37, s37, s35
  s_lshl_b32 s37, s37, 10
  s_add_u32 s37, s37, 0xe00000
  s_mul_i32 s38, s33, 32
  s_add_u32 s38, s38, s35
  s_lshl_b32 s38, s38, 10
  s_add_u32 s38, s38, 0x1a00000
  s_mul_i32 s39, s34, 32
  s_add_u32 s39, s39, s35
  s_lshl_b32 s39, s39, 10
  s_add_u32 s39, s39, 0x1a00000
  s_waitcnt lgkmcnt(0)
  s_barrier
  ds_read_b128 v[40:43], v6
  ds_read_b128 v[44:47], v6 offset:1024
  ds_read_b32 v48, v121
  s_waitcnt lgkmcnt(0)
  v_add_f32 v88, v88, v40
  v_add_f32 v89, v89, v41
  v_add_f32 v90, v90, v42
  v_add_f32 v91, v91, v43
  v_add_f32 v92, v92, v44
  v_add_f32 v93, v93, v45
  v_add_f32 v94, v94, v46
  v_add_f32 v95, v95, v47
  v_add_f32 v96, v96, v48
  v_mov_b32 v121, 0x21800000
  v_cmp_nlt_f32 vcc, v121, v96
  v_mov_b32 v121, 0x5d800000
  v_cmp_ngt_f32 s[66:67], v121, v96
  s_nop 1
  s_or_b64 s[66:67], vcc, s[66:67]
  s_cbranch_scc0 att_fin
  s_add_u32 s64, s25, 0xa00000
  v_mov_b32 v121, 0xff800000
  s_mov_b32 s32, 0
att_max_loop:
  buffer_load_dwordx4 v[16:19], v4, s[4:7], s64 offen
  s_waitcnt vmcnt(0)
  v_mfma_f32_32x32x16_bf16 v[40:55], v[16:19], v[8:11], 0
  s_nop 15
  s_nop 3
  v_max3_f32 v121, v121, v40, v41
  v_max3_f32 v121, v121, v42, v43
  v_max3_f32 v121, v121, v44, v45
  v_max3_f32 v121, v121, v46, v47
  v_max3_f32 v121, v121, v48, v49
  v_max3_f32 v121, v121, v50, v51
  v_max3_f32 v121, v121, v52, v53
  v_max3_f32 v121, v121, v54, v55
  s_add_u32 s64, s64, 1024
  s_add_u32 s32, s32, 1
  s_cmp_lt_u32 s32, 64
  s_cbranch_scc1 att_max_loop
  v_mov_b32 v40, v121
  s_nop 1
  v_permlane32_swap_b32 v121, v40
  s_nop 1
  v_max_f32 v121, v121, v40
  v_sub_f32 v104, 0, v121
  v_mov_b32 v88, 0
  v_sub_f32 v105, 0, v121
  v_mov_b32 v89, 0
  v_sub_f32 v106, 0, v121
  v_mov_b32 v90, 0
  v_sub_f32 v107, 0, v121
  v_mov_b32 v91, 0
  v_sub_f32 v108, 0, v121
  v_mov_b32 v92, 0
  v_sub_f32 v109, 0, v121
  v_mov_b32 v93, 0
  v_sub_f32 v110, 0, v121
  v_mov_b32 v94, 0
  v_sub_f32 v111, 0, v121
  v_mov_b32 v95, 0
  v_sub_f32 v112, 0, v121
  v_mov_b32 v96, 0
  v_sub_f32 v113, 0, v121
  v_mov_b32 v97, 0
  v_sub_f32 v114, 0, v121
  v_mov_b32 v98, 0
  v_sub_f32 v115, 0, v121
  v_mov_b32 v99, 0
  v_sub_f32 v116, 0, v121
  v_mov_b32 v100, 0
  v_sub_f32 v117, 0, v121
  v_mov_b32 v101, 0
  v_sub_f32 v118, 0, v121
  v_mov_b32 v102, 0
  v_sub_f32 v119, 0, v121
  v_mov_b32 v103, 0
  v_mov_b32 v24, 0x3f803f80
  v_mov_b32 v25, 0x3f803f80
  v_mov_b32 v26, 0x3f803f80
  v_mov_b32 v27, 0x3f803f80
  v_mov_b32 v28, 0x3f803f80
  v_mov_b32 v29, 0x3f803f80
  v_mov_b32 v30, 0x3f803f80
  v_mov_b32 v31, 0x3f803f80
  v_and_b32 v6, 15, v1
  v_lshlrev_b32 v6, 4, v6
  v_lshl_add_u32 v6, v3, 8, v6
  s_add_u32 s64, s25, 0xa00000
  s_add_u32 s66, s25, 0xc00000
  s_mov_b32 s82, 0x0000ffff
  s_mov_b32 s83, 0x0000ffff
  s_mov_b32 s32, 0
att_slow_loop:
  buffer_load_dwordx4 v[16:19], v4, s[4:7], s64 offen
  s_mov_b64 exec, s[82:83]
  buffer_load_dwordx4 v[24:27], v6, s[4:7], s66 offen
  buffer_load_dwordx4 v[28:31], v6, s[4:7], s66 offen offset:512
  s_mov_b64 exec, -1
  s_waitcnt vmcnt(0)
  v_mfma_f32_32x32x16_bf16 v[40:55], v[16:19], v[8:11], v[104:119]
  s_nop 15
  s_nop 3
  v_exp_f32 v40, v40
  v_exp_f32 v41, v41
  v_exp_f32 v42, v42
  v_exp_f32 v43, v43
  v_exp_f32 v44, v44
  v_exp_f32 v45, v45
  v_exp_f32 v46, v46
  v_exp_f32 v47, v47
  v_exp_f32 v48, v48
  v_exp_f32 v49, v49
  v_exp_f32 v50, v50
  v_exp_f32 v51, v51
  v_exp_f32 v52, v52
  v_exp_f32 v53, v53
  v_exp_f32 v54, v54
  v_exp_f32 v55, v55
  s_nop 0
  v_cvt_pk_bf16_f32 v72, v40, v41
  v_cvt_pk_bf16_f32 v73, v42, v43
  v_cvt_pk_bf16_f32 v74, v44, v45
  v_cvt_pk_bf16_f32 v75, v46, v47
  v_cvt_pk_bf16_f32 v76, v48, v49
  v_cvt_pk_bf16_f32 v77, v50, v51
  v_cvt_pk_bf16_f32 v78, v52, v53
  v_cvt_pk_bf16_f32 v79, v54, v55
  s_nop 1
  v_mfma_f32_32x32x16_bf16 v[88:103], v[24:27], v[72:75], v[88:103]
  v_mfma_f32_32x32x16_bf16 v[88:103], v[28:31], v[76:79], v[88:103]
  s_add_u32 s64, s64, 1024
  s_add_u32 s66, s66, 1024
  s_add_u32 s32, s32, 1
  s_cmp_lt_u32 s32, 64
  s_cbranch_scc1 att_slow_loop
  s_nop 15
  s_nop 3
att_fin:
  v_rcp_f32 v121, v96
  s_nop 0
  v_mul_f32 v88, v121, v88
  v_mul_f32 v89, v121, v89
  v_mul_f32 v90, v121, v90
  v_mul_f32 v91, v121, v91
  v_mul_f32 v92, v121, v92
  v_mul_f32 v93, v121, v93
  v_mul_f32 v94, v121, v94
  v_mul_f32 v95, v121, v95
  v_cvt_pk_bf16_f32 v88, v88, v89
  v_cvt_pk_bf16_f32 v89, v90, v91
  v_cvt_pk_bf16_f32 v90, v92, v93
  v_cvt_pk_bf16_f32 v91, v94, v95
  buffer_store_dwordx4 v[88:91], v4, s[4:7], s65 offen
  s_waitcnt vmcnt(0)
  s_add_u32 s15, s15, 1
  s_lshl_b32 s86, s12, 7
  s_add_u32 s86, s86, 0x2200400
  s_lshl_b32 s87, s13, 2
  s_add_u32 s87, s87, s86
  v_mov_b32 v120, 0
  v_mov_b32 v121, s15
  v_lshlrev_b32 v122, 2, v1
  s_barrier
  s_cmp_eq_u32 s3, 0
  s_cbranch_scc0 lb1_30_not0
  s_mov_b64 exec, 1
  s_cmp_eq_u32 s18, 0
  s_cbranch_scc1 lb1_30_fast
  buffer_wbl2 sc1
  s_waitcnt vmcnt(0)
  buffer_store_dword v121, v120, s[4:7], s87 offen sc1
  s_branch lb1_30_sent
lb1_30_fast:
  buffer_store_dword v121, v120, s[4:7], s87 offen
lb1_30_sent:
  s_mov_b32 exec_lo, 0xffffffff
  s_mov_b32 exec_hi, 0
  s_mov_b32 s88, 0
lb1_30_p1:
  buffer_load_dword v123, v122, s[4:7], s86 offen sc1
  s_waitcnt vmcnt(0)
  v_subrev_u32 v123, s15, v123
  v_cmp_le_u32 vcc, 64, v123
  s_add_u32 s88, s88, 1
  s_nop 1
  s_cmp_eq_u64 vcc, 0
  s_cbranch_scc1 lb1_30_p1_ok
  s_cmp_lt_u32 s88, 400000
  s_cbranch_scc1 lb1_30_p1
lb1_30_p1_ok:
  s_cmp_eq_u32 s18, 0
  s_cbranch_scc1 lb1_30_noinv
  buffer_inv sc1
  s_waitcnt vmcnt(0)
lb1_30_noinv:
  s_mov_b64 exec, -1
  s_branch lb1_30_join
lb1_30_not0:
lb1_30_join:
  s_barrier
  s_cmp_ge_u32 s3, 4
  s_cbranch_scc1 wo_S
  buffer_load_dwordx4 v[80:83], v4, s[4:7], s36 offen offset:0 sc1
  buffer_load_dwordx4 v[84:87], v4, s[4:7], s38 offen offset:0
  buffer_load_dwordx4 v[88:91], v4, s[4:7], s37 offen offset:0 sc1
  buffer_load_dwordx4 v[92:95], v4, s[4:7], s39 offen offset:0
  buffer_load_dwordx4 v[96:99], v4, s[4:7], s36 offen offset:1024 sc1
  buffer_load_dwordx4 v[100:103], v4, s[4:7], s38 offen offset:1024
  buffer_load_dwordx4 v[104:107], v4, s[4:7], s37 offen offset:1024 sc1
  buffer_load_dwordx4 v[108:111], v4, s[4:7], s39 offen offset:1024
  buffer_load_dwordx4 v[112:115], v4, s[4:7], s36 offen offset:2048 sc1
  buffer_load_dwordx4 v[116:119], v4, s[4:7], s38 offen offset:2048
  buffer_load_dwordx4 v[120:123], v4, s[4:7], s37 offen offset:2048 sc1
  buffer_load_dwordx4 a[104:107], v4, s[4:7], s39 offen offset:2048
  buffer_load_dwordx4 a[108:111], v4, s[4:7], s36 offen offset:3072 sc1
  buffer_load_dwordx4 a[112:115], v4, s[4:7], s38 offen offset:3072
  buffer_load_dwordx4 a[116:119], v4, s[4:7], s37 offen offset:3072 sc1
  buffer_load_dwordx4 a[120:123], v4, s[4:7], s39 offen offset:3072
  s_add_u32 s36, s36, 4096
  s_add_u32 s37, s37, 4096
  s_add_u32 s38, s38, 4096
  s_add_u32 s39, s39, 4096
  s_waitcnt vmcnt(12)
  v_mfma_f32_32x32x16_bf16 v[16:31], v[84:87], v[80:83], 0
  v_mfma_f32_32x32x16_bf16 v[32:47], v[92:95], v[80:83], 0
  v_mfma_f32_32x32x16_bf16 v[48:63], v[84:87], v[88:91], 0
  v_mfma_f32_32x32x16_bf16 v[64:79], v[92:95], v[88:91], 0
  buffer_load_dwordx4 v[80:83], v4, s[4:7], s36 offen offset:0 sc1
  buffer_load_dwordx4 v[84:87], v4, s[4:7], s38 offen offset:0
  buffer_load_dwordx4 v[88:91], v4, s[4:7], s37 offen offset:0 sc1
  buffer_load_dwordx4 v[92:95], v4, s[4:7], s39 offen offset:0
  s_waitcnt vmcnt(12)
  v_mfma_f32_32x32x16_bf16 v[16:31], v[100:103], v[96:99], v[16:31]
  v_mfma_f32_32x32x16_bf16 v[32:47], v[108:111], v[96:99], v[32:47]
  v_mfma_f32_32x32x16_bf16 v[48:63], v[100:103], v[104:107], v[48:63]
  v_mfma_f32_32x32x16_bf16 v[64:79], v[108:111], v[104:107], v[64:79]
  buffer_load_dwordx4 v[96:99], v4, s[4:7], s36 offen offset:1024 sc1
  buffer_load_dwordx4 v[100:103], v4, s[4:7], s38 offen offset:1024
  buffer_load_dwordx4 v[104:107], v4, s[4:7], s37 offen offset:1024 sc1
  buffer_load_dwordx4 v[108:111], v4, s[4:7], s39 offen offset:1024
  s_waitcnt vmcnt(12)
  v_mfma_f32_32x32x16_bf16 v[16:31], v[116:119], v[112:115], v[16:31]
  v_mfma_f32_32x32x16_bf16 v[32:47], a[104:107], v[112:115], v[32:47]
  v_mfma_f32_32x32x16_bf16 v[48:63], v[116:119], v[120:123], v[48:63]
  v_mfma_f32_32x32x16_bf16 v[64:79], a[104:107], v[120:123], v[64:79]
  buffer_load_dwordx4 v[112:115], v4, s[4:7], s36 offen offset:2048 sc1
  buffer_load_dwordx4 v[116:119], v4, s[4:7], s38 offen offset:2048
  buffer_load_dwordx4 v[120:123], v4, s[4:7], s37 offen offset:2048 sc1
  buffer_load_dwordx4 a[104:107], v4, s[4:7], s39 offen offset:2048
  s_waitcnt vmcnt(12)
  v_mfma_f32_32x32x16_bf16 v[16:31], a[112:115], a[108:111], v[16:31]
  v_mfma_f32_32x32x16_bf16 v[32:47], a[120:123], a[108:111], v[32:47]
  v_mfma_f32_32x32x16_bf16 v[48:63], a[112:115], a[116:119], v[48:63]
  v_mfma_f32_32x32x16_bf16 v[64:79], a[120:123], a[116:119], v[64:79]
  buffer_load_dwordx4 a[108:111], v4, s[4:7], s36 offen offset:3072 sc1
  buffer_load_dwordx4 a[112:115], v4, s[4:7], s38 offen offset:3072
  buffer_load_dwordx4 a[116:119], v4, s[4:7], s37 offen offset:3072 sc1
  buffer_load_dwordx4 a[120:123], v4, s[4:7], s39 offen offset:3072
  s_add_u32 s36, s36, 4096
  s_add_u32 s37, s37, 4096
  s_add_u32 s38, s38, 4096
  s_add_u32 s39, s39, 4096
  buffer_load_dwordx4 v[8:11], v4, s[4:7], s41 offen sc1
  buffer_load_dwordx4 v[12:15], v4, s[4:7], s41 offen offset:1024 sc1
  s_waitcnt vmcnt(14)
  v_mfma_f32_32x32x16_bf16 v[16:31], v[84:87], v[80:83], v[16:31]
  v_mfma_f32_32x32x16_bf16 v[32:47], v[92:95], v[80:83], v[32:47]
  v_mfma_f32_32x32x16_bf16 v[48:63], v[84:87], v[88:91], v[48:63]
  v_mfma_f32_32x32x16_bf16 v[64:79], v[92:95], v[88:91], v[64:79]
  s_waitcnt vmcnt(10)
  v_mfma_f32_32x32x16_bf16 v[16:31], v[100:103], v[96:99], v[16:31]
  v_mfma_f32_32x32x16_bf16 v[32:47], v[108:111], v[96:99], v[32:47]
  v_mfma_f32_32x32x16_bf16 v[48:63], v[100:103], v[104:107], v[48:63]
  v_mfma_f32_32x32x16_bf16 v[64:79], v[108:111], v[104:107], v[64:79]
  s_waitcnt vmcnt(6)
  v_mfma_f32_32x32x16_bf16 v[16:31], v[116:119], v[112:115], v[16:31]
  v_mfma_f32_32x32x16_bf16 v[32:47], a[104:107], v[112:115], v[32:47]
  v_mfma_f32_32x32x16_bf16 v[48:63], v[116:119], v[120:123], v[48:63]
  v_mfma_f32_32x32x16_bf16 v[64:79], a[104:107], v[120:123], v[64:79]
  s_waitcnt vmcnt(2)
  v_mfma_f32_32x32x16_bf16 v[16:31], a[112:115], a[108:111], v[16:31]
  v_mfma_f32_32x32x16_bf16 v[32:47], a[120:123], a[108:111], v[32:47]
  v_mfma_f32_32x32x16_bf16 v[48:63], a[112:115], a[116:119], v[48:63]
  v_mfma_f32_32x32x16_bf16 v[64:79], a[120:123], a[116:119], v[64:79]
  s_nop 15
  s_nop 3
  s_xor_b32 s45, s3, 1
  s_mul_i32 s45, s45, 12288
  s_add_u32 s45, s45, 98304
  v_add_u32 v5, s45, v4
  ds_write_b128 v5, v[32:35] offset:0
  ds_write_b128 v5, v[36:39] offset:1024
  ds_write_b128 v5, v[40:43] offset:2048
  ds_write_b128 v5, v[44:47] offset:3072
  s_xor_b32 s45, s3, 2
  s_mul_i32 s45, s45, 12288
  s_add_u32 s45, s45, 102400
  v_add_u32 v5, s45, v4
  ds_write_b128 v5, v[48:51] offset:0
  ds_write_b128 v5, v[52:55] offset:1024
  ds_write_b128 v5, v[56:59] offset:2048
  ds_write_b128 v5, v[60:63] offset:3072
  s_xor_b32 s45, s3, 3
  s_mul_i32 s45, s45, 12288
  s_add_u32 s45, s45, 106496
  v_add_u32 v5, s45, v4
  ds_write_b128 v5, v[64:67] offset:0
  ds_write_b128 v5, v[68:71] offset:1024
  ds_write_b128 v5, v[72:75] offset:2048
  ds_write_b128 v5, v[76:79] offset:3072
  s_mul_i32 s45, s3, 12288
  s_add_u32 s45, s45, 98304
  v_add_u32 v5, s45, v4
  s_waitcnt lgkmcnt(0)
  s_barrier
  ds_read_b128 v[32:35], v5 offset:0
  ds_read_b128 v[36:39], v5 offset:1024
  ds_read_b128 v[40:43], v5 offset:2048
  ds_read_b128 v[44:47], v5 offset:3072
  ds_read_b128 v[48:51], v5 offset:4096
  ds_read_b128 v[52:55], v5 offset:5120
  ds_read_b128 v[56:59], v5 offset:6144
  ds_read_b128 v[60:63], v5 offset:7168
  ds_read_b128 v[64:67], v5 offset:8192
  ds_read_b128 v[68:71], v5 offset:9216
  ds_read_b128 v[72:75], v5 offset:10240
  ds_read_b128 v[76:79], v5 offset:11264
  s_waitcnt lgkmcnt(8)
  v_pk_add_f32 v[16:17], v[16:17], v[32:33]
  v_pk_add_f32 v[18:19], v[18:19], v[34:35]
  v_pk_add_f32 v[20:21], v[20:21], v[36:37]
  v_pk_add_f32 v[22:23], v[22:23], v[38:39]
  v_pk_add_f32 v[24:25], v[24:25], v[40:41]
  v_pk_add_f32 v[26:27], v[26:27], v[42:43]
  v_pk_add_f32 v[28:29], v[28:29], v[44:45]
  v_pk_add_f32 v[30:31], v[30:31], v[46:47]
  s_waitcnt lgkmcnt(4)
  v_pk_add_f32 v[16:17], v[16:17], v[48:49]
  v_pk_add_f32 v[18:19], v[18:19], v[50:51]
  v_pk_add_f32 v[20:21], v[20:21], v[52:53]
  v_pk_add_f32 v[22:23], v[22:23], v[54:55]
  v_pk_add_f32 v[24:25], v[24:25], v[56:57]
  v_pk_add_f32 v[26:27], v[26:27], v[58:59]
  v_pk_add_f32 v[28:29], v[28:29], v[60:61]
  v_pk_add_f32 v[30:31], v[30:31], v[62:63]
  s_waitcnt lgkmcnt(0)
  v_pk_add_f32 v[16:17], v[16:17], v[64:65]
  v_pk_add_f32 v[18:19], v[18:19], v[66:67]
  v_pk_add_f32 v[20:21], v[20:21], v[68:69]
  v_pk_add_f32 v[22:23], v[22:23], v[70:71]
  v_pk_add_f32 v[24:25], v[24:25], v[72:73]
  v_pk_add_f32 v[26:27], v[26:27], v[74:75]
  v_pk_add_f32 v[28:29], v[28:29], v[76:77]
  v_pk_add_f32 v[30:31], v[30:31], v[78:79]
  s_waitcnt vmcnt(0)
  v_lshlrev_b32 v32, 16, v8
  v_and_b32 v33, 0xffff0000, v8
  v_lshlrev_b32 v34, 16, v9
  v_and_b32 v35, 0xffff0000, v9
  v_lshlrev_b32 v36, 16, v10
  v_and_b32 v37, 0xffff0000, v10
  v_lshlrev_b32 v38, 16, v11
  v_and_b32 v39, 0xffff0000, v11
  v_lshlrev_b32 v40, 16, v12
  v_and_b32 v41, 0xffff0000, v12
  v_lshlrev_b32 v42, 16, v13
  v_and_b32 v43, 0xffff0000, v13
  v_lshlrev_b32 v44, 16, v14
  v_and_b32 v45, 0xffff0000, v14
  v_lshlrev_b32 v46, 16, v15
  v_and_b32 v47, 0xffff0000, v15
  v_pk_add_f32 v[16:17], v[16:17], v[32:33]
  v_pk_add_f32 v[18:19], v[18:19], v[34:35]
  v_pk_add_f32 v[20:21], v[20:21], v[36:37]
  v_pk_add_f32 v[22:23], v[22:23], v[38:39]
  v_pk_add_f32 v[24:25], v[24:25], v[40:41]
  v_pk_add_f32 v[26:27], v[26:27], v[42:43]
  v_pk_add_f32 v[28:29], v[28:29], v[44:45]
  v_pk_add_f32 v[30:31], v[30:31], v[46:47]
  v_cvt_pk_bf16_f32 v8, v16, v17
  v_cvt_pk_bf16_f32 v9, v18, v19
  v_cvt_pk_bf16_f32 v10, v20, v21
  v_cvt_pk_bf16_f32 v11, v22, v23
  v_cvt_pk_bf16_f32 v12, v24, v25
  v_cvt_pk_bf16_f32 v13, v26, v27
  v_cvt_pk_bf16_f32 v14, v28, v29
  v_cvt_pk_bf16_f32 v15, v30, v31
  buffer_store_dwordx4 v[8:11], v4, s[4:7], s44 offen
  buffer_store_dwordx4 v[12:15], v4, s[4:7], s44 offen offset:1024
  v_mov_b32 v16, 0
  v_mov_b32 v17, 0
  v_mov_b32 v5, 0x3f803f80
  v_dot2c_f32_bf16 v16, v8, v5
  v_dot2c_f32_bf16 v17, v8, v8
  v_dot2c_f32_bf16 v16, v9, v5
  v_dot2c_f32_bf16 v17, v9, v9
  v_dot2c_f32_bf16 v16, v10, v5
  v_dot2c_f32_bf16 v17, v10, v10
  v_dot2c_f32_bf16 v16, v11, v5
  v_dot2c_f32_bf16 v17, v11, v11
  v_dot2c_f32_bf16 v16, v12, v5
  v_dot2c_f32_bf16 v17, v12, v12
  v_dot2c_f32_bf16 v16, v13, v5
  v_dot2c_f32_bf16 v17, v13, v13
  v_dot2c_f32_bf16 v16, v14, v5
  v_dot2c_f32_bf16 v17, v14, v14
  v_dot2c_f32_bf16 v16, v15, v5
  v_dot2c_f32_bf16 v17, v15, v15
  s_nop 4
  v_mov_b32 v5, v16
  s_nop 1
  v_permlane32_swap_b32 v16, v5
  s_nop 1
  v_add_f32 v16, v16, v5
  v_mov_b32 v5, v17
  s_nop 1
  v_permlane32_swap_b32 v17, v5
  s_nop 1
  v_add_f32 v17, v17, v5
  v_lshlrev_b32 v5, 7, v2
  s_nop 0
  buffer_store_dwordx2 v[16:17], v5, s[4:7], s42 offen
  s_lshr_b32 s22, s13, 4
  s_lshl_b32 s24, s12, 1
  s_add_u32 s22, s22, s24
  s_and_b32 s23, s13, 15
  s_and_b32 s24, s3, 3
  s_lshl_b32 s25, s22, 2
  s_add_u32 s24, s24, s25
  s_lshl_b32 s25, s24, 15
  v_lshlrev_b32 v7, 7, v2
  v_lshl_add_u32 v7, v3, 6, v7
  s_lshl_b32 s31, s24, 12
  s_add_u32 s31, s31, 0x2000000
  v_mov_b32 v9, v4
  v_add_u32 v10, 0x10000, v4
  s_waitcnt vmcnt(0)
  s_branch wo_done
wo_S:
  s_barrier
wo_done:
  s_add_u32 s15, s15, 1
  s_lshl_b32 s86, s12, 7
  s_add_u32 s86, s86, 0x2200400
  s_lshl_b32 s87, s13, 2
  s_add_u32 s87, s87, s86
  v_mov_b32 v120, 0
  v_mov_b32 v121, s15
  v_lshlrev_b32 v122, 2, v1
  s_barrier
  s_cmp_eq_u32 s3, 0
  s_cbranch_scc0 lb2_31_not0
  s_mov_b64 exec, 1
  s_cmp_eq_u32 s18, 0
  s_cbranch_scc1 lb2_31_fast
  buffer_wbl2 sc1
  s_waitcnt vmcnt(0)
  buffer_store_dword v121, v120, s[4:7], s87 offen sc1
  s_branch lb2_31_sent
lb2_31_fast:
  buffer_store_dword v121, v120, s[4:7], s87 offen
lb2_31_sent:
  s_lshr_b32 s89, s13, 4
  s_lshl_b32 s89, s89, 6
  s_add_u32 s86, s86, s89
  s_mov_b32 exec_lo, 0xffff
  s_mov_b32 exec_hi, 0
  s_mov_b32 s88, 0
lb2_31_p1:
  buffer_load_dword v123, v122, s[4:7], s86 offen sc1
  s_waitcnt vmcnt(0)
  v_subrev_u32 v123, s15, v123
  v_cmp_le_u32 vcc, 64, v123
  s_add_u32 s88, s88, 1
  s_nop 1
  s_cmp_eq_u64 vcc, 0
  s_cbranch_scc1 lb2_31_p1_ok
  s_cmp_lt_u32 s88, 400000
  s_cbranch_scc1 lb2_31_p1
lb2_31_p1_ok:
  s_cmp_eq_u32 s18, 0
  s_cbranch_scc1 lb2_31_noinv
  buffer_inv sc1
  s_waitcnt vmcnt(0)
lb2_31_noinv:
  s_mov_b64 exec, -1
  s_branch lb2_31_join
lb2_31_not0:
lb2_31_join:
  s_barrier
  s_cmp_ge_u32 s3, 4
  s_cbranch_scc1 ffn1_S
  s_and_b32 s46, s13, 15
  s_cmp_ge_u32 s46, 14
  s_cbranch_scc1 ffn1_idle
  buffer_load_dwordx4 a[104:107], v4, s[4:7], s25 offen offset:0 sc1
  buffer_load_dwordx4 a[108:111], v4, s[4:7], s25 offen offset:1024 sc1
  buffer_load_dwordx4 a[112:115], v4, s[4:7], s25 offen offset:2048 sc1
  buffer_load_dwordx4 a[116:119], v4, s[4:7], s25 offen offset:3072 sc1
  s_add_u32 s25, s25, 4096
  buffer_load_dwordx4 a[120:123], v4, s[4:7], s25 offen offset:0 sc1
  buffer_load_dwordx4 a[124:127], v4, s[4:7], s25 offen offset:1024 sc1
  buffer_load_dwordx4 v[12:15], v7, s[4:7], s31 offen offset:0 sc1
  buffer_load_dwordx4 v[16:19], v7, s[4:7], s31 offen offset:16 sc1
  buffer_load_dwordx4 v[20:23], v7, s[4:7], s31 offen offset:32 sc1
  buffer_load_dwordx4 v[24:27], v7, s[4:7], s31 offen offset:48 sc1
  ds_read_b128 v[92:95], v9 offset:0
  ds_read_b128 v[96:99], v9 offset:4096
  ds_read_b128 v[100:103], v9 offset:8192
  ds_read_b128 v[104:107], v9 offset:12288
  ds_read_b128 v[108:111], v9 offset:1024
  ds_read_b128 v[112:115], v9 offset:5120
  ds_read_b128 v[116:119], v9 offset:9216
  s_waitcnt vmcnt(9)
  s_waitcnt lgkmcnt(6)
  v_mfma_f32_32x32x16_bf16 v[28:43], v[92:95], a[104:107], 0
  ds_read_b128 v[120:123], v9 offset:13312
  s_waitcnt lgkmcnt(6)
  v_mfma_f32_32x32x16_bf16 v[44:59], v[96:99], a[104:107], 0
  ds_read_b128 v[92:95], v9 offset:2048
  s_waitcnt lgkmcnt(6)
  v_mfma_f32_32x32x16_bf16 v[60:75], v[100:103], a[104:107], 0
  ds_read_b128 v[96:99], v9 offset:6144
  s_waitcnt lgkmcnt(6)
  v_mfma_f32_32x32x16_bf16 v[76:91], v[104:107], a[104:107], 0
  ds_read_b128 v[100:103], v9 offset:10240
  s_waitcnt vmcnt(8)
  s_waitcnt lgkmcnt(6)
  v_mfma_f32_32x32x16_bf16 v[28:43], v[108:111], a[108:111], v[28:43]
  ds_read_b128 v[104:107], v9 offset:14336
  buffer_load_dwordx4 a[104:107], v4, s[4:7], s25 offen offset:2048 sc1
  s_waitcnt lgkmcnt(6)
  v_mfma_f32_32x32x16_bf16 v[44:59], v[112:115], a[108:111], v[44:59]
  ds_read_b128 v[108:111], v9 offset:3072
  s_waitcnt lgkmcnt(6)
  v_mfma_f32_32x32x16_bf16 v[60:75], v[116:119], a[108:111], v[60:75]
  ds_read_b128 v[112:115], v9 offset:7168
  s_waitcnt lgkmcnt(6)
  v_mfma_f32_32x32x16_bf16 v[76:91], v[120:123], a[108:111], v[76:91]
  ds_read_b128 v[116:119], v9 offset:11264
  s_waitcnt vmcnt(8)
  s_waitcnt lgkmcnt(6)
  v_mfma_f32_32x32x16_bf16 v[28:43], v[92:95], a[112:115], v[28:43]
  ds_read_b128 v[120:123], v9 offset:15360
  buffer_load_dwordx4 a[108:111], v4, s[4:7], s25 offen offset:3072 sc1
  s_waitcnt lgkmcnt(6)
  v_mfma_f32_32x32x16_bf16 v[44:59], v[96:99], a[112:115], v[44:59]
  ds_read_b128 v[92:95], v9 offset:16384
  s_waitcnt lgkmcnt(6)
  v_mfma_f32_32x32x16_bf16 v[60:75], v[100:103], a[112:115], v[60:75]
  ds_read_b128 v[96:99], v9 offset:20480
  s_waitcnt lgkmcnt(6)
  v_mfma_f32_32x32x16_bf16 v[76:91], v[104:107], a[112:115], v[76:91]
  ds_read_b128 v[100:103], v9 offset:24576
  s_waitcnt vmcnt(8)
  s_waitcnt lgkmcnt(6)
  v_mfma_f32_32x32x16_bf16 v[28:43], v[108:111], a[116:119], v[28:43]
  ds_read_b128 v[104:107], v9 offset:28672
  s_add_u32 s25, s25, 4096
  buffer_load_dwordx4 a[112:115], v4, s[4:7], s25 offen offset:0 sc1
  s_waitcnt lgkmcnt(6)
  v_mfma_f32_32x32x16_bf16 v[44:59], v[112:115], a[116:119], v[44:59]
  ds_read_b128 v[108:111], v9 offset:17408
  s_waitcnt lgkmcnt(6)
  v_mfma_f32_32x32x16_bf16 v[60:75], v[116:119], a[116:119], v[60:75]
  ds_read_b128 v[112:115], v9 offset:21504
  s_waitcnt lgkmcnt(6)
  v_mfma_f32_32x32x16_bf16 v[76:91], v[120:123], a[116:119], v[76:91]
  ds_read_b128 v[116:119], v9 offset:25600
  s_waitcnt vmcnt(8)
  s_waitcnt lgkmcnt(6)
  v_mfma_f32_32x32x16_bf16 v[28:43], v[92:95], a[120:123], v[28:43]
  ds_read_b128 v[120:123], v9 offset:29696
  buffer_load_dwordx4 a[116:119], v4, s[4:7], s25 offen offset:1024 sc1
  s_waitcnt lgkmcnt(6)
  v_mfma_f32_32x32x16_bf16 v[44:59], v[96:99], a[120:123], v[44:59]
  ds_read_b128 v[92:95], v9 offset:18432
  s_waitcnt lgkmcnt(6)
  v_mfma_f32_32x32x16_bf16 v[60:75], v[100:103], a[120:123], v[60:75]
  ds_read_b128 v[96:99], v9 offset:22528
  s_waitcnt lgkmcnt(6)
  v_mfma_f32_32x32x16_bf16 v[76:91], v[104:107], a[120:123], v[76:91]
  ds_read_b128 v[100:103], v9 offset:26624
  s_barrier
  s_waitcnt vmcnt(8)
  s_waitcnt lgkmcnt(6)
  v_mfma_f32_32x32x16_bf16 v[28:43], v[108:111], a[124:127], v[28:43]
  ds_read_b128 v[104:107], v9 offset:30720
  buffer_load_dwordx4 a[120:123], v4, s[4:7], s25 offen offset:2048 sc1
  s_waitcnt lgkmcnt(6)
  v_mfma_f32_32x32x16_bf16 v[44:59], v[112:115], a[124:127], v[44:59]
  ds_read_b128 v[108:111], v9 offset:19456
  s_waitcnt lgkmcnt(6)
  v_mfma_f32_32x32x16_bf16 v[60:75], v[116:119], a[124:127], v[60:75]
  ds_read_b128 v[112:115], v9 offset:23552
  s_waitcnt lgkmcnt(6)
  v_mfma_f32_32x32x16_bf16 v[76:91], v[120:123], a[124:127], v[76:91]
  ds_read_b128 v[116:119], v9 offset:27648
  s_waitcnt vmcnt(4)
  s_waitcnt lgkmcnt(6)
  v_mfma_f32_32x32x16_bf16 v[28:43], v[92:95], a[104:107], v[28:43]
  ds_read_b128 v[120:123], v9 offset:31744
  buffer_load_dwordx4 a[124:127], v4, s[4:7], s25 offen offset:3072 sc1
  s_waitcnt lgkmcnt(6)
  v_mfma_f32_32x32x16_bf16 v[44:59], v[96:99], a[104:107], v[44:59]
  ds_read_b128 v[92:95], v9 offset:32768
  s_waitcnt lgkmcnt(6)
  v_mfma_f32_32x32x16_bf16 v[60:75], v[100:103], a[104:107], v[60:75]
  ds_read_b128 v[96:99], v9 offset:36864
  s_waitcnt lgkmcnt(6)
  v_mfma_f32_32x32x16_bf16 v[76:91], v[104:107], a[104:107], v[76:91]
  ds_read_b128 v[100:103], v9 offset:40960
  s_waitcnt vmcnt(4)
  s_waitcnt lgkmcnt(6)
  v_mfma_f32_32x32x16_bf16 v[28:43], v[108:111], a[108:111], v[28:43]
  ds_read_b128 v[104:107], v9 offset:45056
  s_add_u32 s25, s25, 4096
  buffer_load_dwordx4 a[104:107], v4, s[4:7], s25 offen offset:0 sc1
  s_waitcnt lgkmcnt(6)
  v_mfma_f32_32x32x16_bf16 v[44:59], v[112:115], a[108:111], v[44:59]
  ds_read_b128 v[108:111], v9 offset:33792
  s_waitcnt lgkmcnt(6)
  v_mfma_f32_32x32x16_bf16 v[60:75], v[116:119], a[108:111], v[60:75]
  ds_read_b128 v[112:115], v9 offset:37888
  s_waitcnt lgkmcnt(6)
  v_mfma_f32_32x32x16_bf16 v[76:91], v[120:123], a[108:111], v[76:91]
  ds_read_b128 v[116:119], v9 offset:41984
  s_waitcnt vmcnt(4)
  s_waitcnt lgkmcnt(6)
  v_mfma_f32_32x32x16_bf16 v[28:43], v[92:95], a[112:115], v[28:43]
  ds_read_b128 v[120:123], v9 offset:46080
  buffer_load_dwordx4 a[108:111], v4, s[4:7], s25 offen offset:1024 sc1
  s_waitcnt lgkmcnt(6)
  v_mfma_f32_32x32x16_bf16 v[44:59], v[96:99], a[112:115], v[44:59]
  ds_read_b128 v[92:95], v9 offset:34816
  s_waitcnt vmcnt(8)
  v_add_f32 v5, v12, v14
  v_add_f32 v6, v13, v15
  s_waitcnt lgkmcnt(6)
  v_mfma_f32_32x32x16_bf16 v[60:75], v[100:103], a[112:115], v[60:75]
  ds_read_b128 v[96:99], v9 offset:38912
  v_add_f32 v5, v5, v16
  v_add_f32 v6, v6, v17
  s_waitcnt lgkmcnt(6)
  v_mfma_f32_32x32x16_bf16 v[76:91], v[104:107], a[112:115], v[76:91]
  ds_read_b128 v[100:103], v9 offset:43008
  v_add_f32 v5, v5, v18
  v_add_f32 v6, v6, v19
  s_waitcnt vmcnt(4)
  s_waitcnt lgkmcnt(6)
  v_mfma_f32_32x32x16_bf16 v[28:43], v[108:111], a[116:119], v[28:43]
  ds_read_b128 v[104:107], v9 offset:47104
  buffer_load_dwordx4 a[112:115], v4, s[4:7], s25 offen offset:2048 sc1
  s_waitcnt lgkmcnt(6)
  v_mfma_f32_32x32x16_bf16 v[44:59], v[112:115], a[116:119], v[44:59]
  ds_read_b128 v[108:111], v9 offset:35840
  v_add_f32 v5, v5, v20
  v_add_f32 v6, v6, v21
  s_waitcnt lgkmcnt(6)
  v_mfma_f32_32x32x16_bf16 v[60:75], v[116:119], a[116:119], v[60:75]
  ds_read_b128 v[112:115], v9 offset:39936
  v_add_f32 v5, v5, v22
  v_add_f32 v6, v6, v23
  s_waitcnt lgkmcnt(6)
  v_mfma_f32_32x32x16_bf16 v[76:91], v[120:123], a[116:119], v[76:91]
  ds_read_b128 v[116:119], v9 offset:44032
  v_add_f32 v5, v5, v24
  v_add_f32 v6, v6, v25
  s_waitcnt vmcnt(4)
  s_waitcnt lgkmcnt(6)
  v_mfma_f32_32x32x16_bf16 v[28:43], v[92:95], a[120:123], v[28:43]
  ds_read_b128 v[120:123], v9 offset:48128
  buffer_load_dwordx4 a[116:119], v4, s[4:7], s25 offen offset:3072 sc1
  s_waitcnt lgkmcnt(6)
  v_mfma_f32_32x32x16_bf16 v[44:59], v[96:99], a[120:123], v[44:59]
  ds_read_b128 v[92:95], v9 offset:49152
  v_add_f32 v5, v5, v26
  v_add_f32 v6, v6, v27
  s_waitcnt lgkmcnt(6)
  v_mfma_f32_32x32x16_bf16 v[60:75], v[100:103], a[120:123], v[60:75]
  ds_read_b128 v[96:99], v9 offset:53248
  v_mov_b32 v8, v5
  s_nop 1
  s_waitcnt lgkmcnt(6)
  v_mfma_f32_32x32x16_bf16 v[76:91], v[104:107], a[120:123], v[76:91]
  ds_read_b128 v[100:103], v9 offset:57344
  v_permlane32_swap_b32 v5, v8
  s_nop 1
  s_waitcnt vmcnt(4)
  s_waitcnt lgkmcnt(6)
  v_mfma_f32_32x32x16_bf16 v[28:43], v[108:111], a[124:127], v[28:43]
  ds_read_b128 v[104:107], v9 offset:61440
  s_add_u32 s25, s25, 4096
  buffer_load_dwordx4 a[120:123], v4, s[4:7], s25 offen offset:0 sc1
  s_waitcnt lgkmcnt(6)
  v_mfma_f32_32x32x16_bf16 v[44:59], v[112:115], a[124:127], v[44:59]
  ds_read_b128 v[108:111], v9 offset:50176
  v_add_f32 v5, v5, v8
  s_waitcnt lgkmcnt(6)
  v_mfma_f32_32x32x16_bf16 v[60:75], v[116:119], a[124:127], v[60:75]
  ds_read_b128 v[112:115], v9 offset:54272
  v_mov_b32 v8, v6
  s_nop 1
  s_waitcnt lgkmcnt(6)
  v_mfma_f32_32x32x16_bf16 v[76:91], v[120:123], a[124:127], v[76:91]
  ds_read_b128 v[116:119], v9 offset:58368
  v_permlane32_swap_b32 v6, v8
  s_nop 1
  s_waitcnt vmcnt(4)
  s_waitcnt lgkmcnt(6)
  v_mfma_f32_32x32x16_bf16 v[28:43], v[92:95], a[104:107], v[28:43]
  ds_read_b128 v[120:123], v9 offset:62464
  buffer_load_dwordx4 a[124:127], v4, s[4:7], s25 offen offset:1024 sc1
  s_waitcnt lgkmcnt(6)
  v_mfma_f32_32x32x16_bf16 v[44:59], v[96:99], a[104:107], v[44:59]
  ds_read_b128 v[92:95], v9 offset:51200
  v_add_f32 v6, v6, v8
  s_waitcnt lgkmcnt(6)
  v_mfma_f32_32x32x16_bf16 v[60:75], v[100:103], a[104:107], v[60:75]
  ds_read_b128 v[96:99], v9 offset:55296
  v_mul_f32 v5, 0x3b000000, v5
  v_mul_f32 v6, 0x3b000000, v6
  s_waitcnt lgkmcnt(6)
  v_mfma_f32_32x32x16_bf16 v[76:91], v[104:107], a[104:107], v[76:91]
  ds_read_b128 v[100:103], v9 offset:59392
  v_fma_f32 v6, -v5, v5, v6
  v_sub_f32 v12, 0, v5
  s_waitcnt vmcnt(4)
  s_waitcnt lgkmcnt(6)
  v_mfma_f32_32x32x16_bf16 v[28:43], v[108:111], a[108:111], v[28:43]
  ds_read_b128 v[104:107], v9 offset:63488
  buffer_load_dwordx4 a[104:107], v4, s[4:7], s25 offen offset:2048 sc1
  s_waitcnt lgkmcnt(6)
  v_mfma_f32_32x32x16_bf16 v[44:59], v[112:115], a[108:111], v[44:59]
  ds_read_b128 v[108:111], v9 offset:52224
  v_max_f32 v6, 0, v6
  v_lshlrev_b32 v18, 4, v3
  s_waitcnt lgkmcnt(6)
  v_mfma_f32_32x32x16_bf16 v[60:75], v[116:119], a[108:111], v[60:75]
  ds_read_b128 v[112:115], v9 offset:56320
  v_add_f32 v6, 0x3727c5ac, v6
  v_add_u32 v19, 0x20000, v18
  s_waitcnt lgkmcnt(6)
  v_mfma_f32_32x32x16_bf16 v[76:91], v[120:123], a[108:111], v[76:91]
  ds_read_b128 v[116:119], v9 offset:60416
  v_rsq_f32 v14, v6
  s_nop 0
  s_waitcnt vmcnt(4)
  s_waitcnt lgkmcnt(6)
  v_mfma_f32_32x32x16_bf16 v[28:43], v[92:95], a[112:115], v[28:43]
  ds_read_b128 v[120:123], v9 offset:64512
  buffer_load_dwordx4 a[108:111], v4, s[4:7], s25 offen offset:3072 sc1
  s_waitcnt lgkmcnt(6)
  v_mfma_f32_32x32x16_bf16 v[44:59], v[96:99], a[112:115], v[44:59]
  ds_read_b128 v[92:95], v10 offset:0
  v_mul_f32 v16, 0x3eb8aa3b, v14
  s_waitcnt lgkmcnt(6)
  v_mfma_f32_32x32x16_bf16 v[60:75], v[100:103], a[112:115], v[60:75]
  ds_read_b128 v[96:99], v10 offset:4096
  s_waitcnt lgkmcnt(6)
  v_mfma_f32_32x32x16_bf16 v[76:91], v[104:107], a[112:115], v[76:91]
  ds_read_b128 v[100:103], v10 offset:8192
  s_waitcnt vmcnt(4)
  s_waitcnt lgkmcnt(6)
  v_mfma_f32_32x32x16_bf16 v[28:43], v[108:111], a[116:119], v[28:43]
  ds_read_b128 v[104:107], v10 offset:12288
  s_add_u32 s25, s25, 4096
  buffer_load_dwordx4 a[112:115], v4, s[4:7], s25 offen offset:0 sc1
  s_waitcnt lgkmcnt(6)
  v_mfma_f32_32x32x16_bf16 v[44:59], v[112:115], a[116:119], v[44:59]
  ds_read_b128 v[108:111], v10 offset:1024
  s_waitcnt lgkmcnt(6)
  v_mfma_f32_32x32x16_bf16 v[60:75], v[116:119], a[116:119], v[60:75]
  ds_read_b128 v[112:115], v10 offset:5120
  s_waitcnt lgkmcnt(6)
  v_mfma_f32_32x32x16_bf16 v[76:91], v[120:123], a[116:119], v[76:91]
  ds_read_b128 v[116:119], v10 offset:9216
  s_waitcnt vmcnt(4)
  s_waitcnt lgkmcnt(6)
  v_mfma_f32_32x32x16_bf16 v[28:43], v[92:95], a[120:123], v[28:43]
  ds_read_b128 v[120:123], v10 offset:13312
  buffer_load_dwordx4 a[116:119], v4, s[4:7], s25 offen offset:1024 sc1
  s_waitcnt lgkmcnt(6)
  v_mfma_f32_32x32x16_bf16 v[44:59], v[96:99], a[120:123], v[44:59]
  ds_read_b128 v[92:95], v10 offset:2048
  s_waitcnt lgkmcnt(6)
  v_mfma_f32_32x32x16_bf16 v[60:75], v[100:103], a[120:123], v[60:75]
  ds_read_b128 v[96:99], v10 offset:6144
  s_waitcnt lgkmcnt(6)
  v_mfma_f32_32x32x16_bf16 v[76:91], v[104:107], a[120:123], v[76:91]
  ds_read_b128 v[100:103], v10 offset:10240
  s_waitcnt vmcnt(4)
  s_waitcnt lgkmcnt(6)
  v_mfma_f32_32x32x16_bf16 v[28:43], v[108:111], a[124:127], v[28:43]
  ds_read_b128 v[104:107], v10 offset:14336
  buffer_load_dwordx4 a[120:123], v4, s[4:7], s25 offen offset:2048 sc1
  s_waitcnt lgkmcnt(6)
  v_mfma_f32_32x32x16_bf16 v[44:59], v[112:115], a[124:127], v[44:59]
  ds_read_b128 v[108:111], v10 offset:3072
  s_waitcnt lgkmcnt(6)
  v_mfma_f32_32x32x16_bf16 v[60:75], v[116:119], a[124:127], v[60:75]
  ds_read_b128 v[112:115], v10 offset:7168
  s_waitcnt lgkmcnt(6)
  v_mfma_f32_32x32x16_bf16 v[76:91], v[120:123], a[124:127], v[76:91]
  ds_read_b128 v[116:119], v10 offset:11264
  s_waitcnt vmcnt(4)
  s_waitcnt lgkmcnt(6)
  v_mfma_f32_32x32x16_bf16 v[28:43], v[92:95], a[104:107], v[28:43]
  ds_read_b128 v[120:123], v10 offset:15360
  buffer_load_dwordx4 a[124:127], v4, s[4:7], s25 offen offset:3072 sc1
  s_waitcnt lgkmcnt(6)
  v_mfma_f32_32x32x16_bf16 v[44:59], v[96:99], a[104:107], v[44:59]
  s_barrier
  ds_read_b128 v[92:95], v10 offset:16384
  s_waitcnt lgkmcnt(6)
  v_mfma_f32_32x32x16_bf16 v[60:75], v[100:103], a[104:107], v[60:75]
  ds_read_b128 v[96:99], v10 offset:20480
  s_waitcnt lgkmcnt(6)
  v_mfma_f32_32x32x16_bf16 v[76:91], v[104:107], a[104:107], v[76:91]
  ds_read_b128 v[100:103], v10 offset:24576
  s_waitcnt vmcnt(4)
  s_waitcnt lgkmcnt(6)
  v_mfma_f32_32x32x16_bf16 v[28:43], v[108:111], a[108:111], v[28:43]
  ds_read_b128 v[104:107], v10 offset:28672
  s_add_u32 s25, s25, 4096
  buffer_load_dwordx4 a[104:107], v4, s[4:7], s25 offen offset:0 sc1
  s_waitcnt lgkmcnt(6)
  v_mfma_f32_32x32x16_bf16 v[44:59], v[112:115], a[108:111], v[44:59]
  ds_read_b128 v[108:111], v10 offset:17408
  s_waitcnt lgkmcnt(6)
  v_mfma_f32_32x32x16_bf16 v[60:75], v[116:119], a[108:111], v[60:75]
  ds_read_b128 v[112:115], v10 offset:21504
  s_waitcnt lgkmcnt(6)
  v_mfma_f32_32x32x16_bf16 v[76:91], v[120:123], a[108:111], v[76:91]
  ds_read_b128 v[116:119], v10 offset:25600
  s_waitcnt vmcnt(4)
  s_waitcnt lgkmcnt(6)
  v_mfma_f32_32x32x16_bf16 v[28:43], v[92:95], a[112:115], v[28:43]
  ds_read_b128 v[120:123], v10 offset:29696
  buffer_load_dwordx4 a[108:111], v4, s[4:7], s25 offen offset:1024 sc1
  s_waitcnt lgkmcnt(6)
  v_mfma_f32_32x32x16_bf16 v[44:59], v[96:99], a[112:115], v[44:59]
  ds_read_b128 v[92:95], v10 offset:18432
  s_waitcnt lgkmcnt(6)
  v_mfma_f32_32x32x16_bf16 v[60:75], v[100:103], a[112:115], v[60:75]
  ds_read_b128 v[96:99], v10 offset:22528
  s_waitcnt lgkmcnt(6)
  v_mfma_f32_32x32x16_bf16 v[76:91], v[104:107], a[112:115], v[76:91]
  ds_read_b128 v[100:103], v10 offset:26624
  s_waitcnt vmcnt(4)
  s_waitcnt lgkmcnt(6)
  v_mfma_f32_32x32x16_bf16 v[28:43], v[108:111], a[116:119], v[28:43]
  ds_read_b128 v[104:107], v10 offset:30720
  buffer_load_dwordx4 a[112:115], v4, s[4:7], s25 offen offset:2048 sc1
  s_waitcnt lgkmcnt(6)
  v_mfma_f32_32x32x16_bf16 v[44:59], v[112:115], a[116:119], v[44:59]
  ds_read_b128 v[108:111], v10 offset:19456
  s_waitcnt lgkmcnt(6)
  v_mfma_f32_32x32x16_bf16 v[60:75], v[116:119], a[116:119], v[60:75]
  ds_read_b128 v[112:115], v10 offset:23552
  s_waitcnt lgkmcnt(6)
  v_mfma_f32_32x32x16_bf16 v[76:91], v[120:123], a[116:119], v[76:91]
  ds_read_b128 v[116:119], v10 offset:27648
  s_waitcnt vmcnt(4)
  s_waitcnt lgkmcnt(6)
  v_mfma_f32_32x32x16_bf16 v[28:43], v[92:95], a[120:123], v[28:43]
  ds_read_b128 v[120:123], v10 offset:31744
  buffer_load_dwordx4 a[116:119], v4, s[4:7], s25 offen offset:3072 sc1
  s_waitcnt lgkmcnt(6)
  v_mfma_f32_32x32x16_bf16 v[44:59], v[96:99], a[120:123], v[44:59]
  ds_read_b128 v[92:95], v10 offset:32768
  s_waitcnt lgkmcnt(6)
  v_mfma_f32_32x32x16_bf16 v[60:75], v[100:103], a[120:123], v[60:75]
  ds_read_b128 v[96:99], v10 offset:36864
  s_waitcnt lgkmcnt(6)
  v_mfma_f32_32x32x16_bf16 v[76:91], v[104:107], a[120:123], v[76:91]
  ds_read_b128 v[100:103], v10 offset:40960
  s_waitcnt vmcnt(4)
  s_waitcnt lgkmcnt(6)
  v_mfma_f32_32x32x16_bf16 v[28:43], v[108:111], a[124:127], v[28:43]
  ds_read_b128 v[104:107], v10 offset:45056
  s_add_u32 s25, s25, 4096
  buffer_load_dwordx4 a[120:123], v4, s[4:7], s25 offen offset:0 sc1
  s_waitcnt lgkmcnt(6)
  v_mfma_f32_32x32x16_bf16 v[44:59], v[112:115], a[124:127], v[44:59]
  ds_read_b128 v[108:111], v10 offset:33792
  s_waitcnt lgkmcnt(6)
  v_mfma_f32_32x32x16_bf16 v[60:75], v[116:119], a[124:127], v[60:75]
  ds_read_b128 v[112:115], v10 offset:37888
  s_waitcnt lgkmcnt(6)
  v_mfma_f32_32x32x16_bf16 v[76:91], v[120:123], a[124:127], v[76:91]
  ds_read_b128 v[116:119], v10 offset:41984
  s_waitcnt vmcnt(4)
  s_waitcnt lgkmcnt(6)
  v_mfma_f32_32x32x16_bf16 v[28:43], v[92:95], a[104:107], v[28:43]
  ds_read_b128 v[120:123], v10 offset:46080
  buffer_load_dwordx4 a[124:127], v4, s[4:7], s25 offen offset:1024 sc1
  s_waitcnt lgkmcnt(6)
  v_mfma_f32_32x32x16_bf16 v[44:59], v[96:99], a[104:107], v[44:59]
  ds_read_b128 v[92:95], v10 offset:34816
  s_waitcnt lgkmcnt(6)
  v_mfma_f32_32x32x16_bf16 v[60:75], v[100:103], a[104:107], v[60:75]
  ds_read_b128 v[96:99], v10 offset:38912
  s_waitcnt lgkmcnt(6)
  v_mfma_f32_32x32x16_bf16 v[76:91], v[104:107], a[104:107], v[76:91]
  ds_read_b128 v[100:103], v10 offset:43008
  s_waitcnt vmcnt(4)
  s_waitcnt lgkmcnt(6)
  v_mfma_f32_32x32x16_bf16 v[28:43], v[108:111], a[108:111], v[28:43]
  ds_read_b128 v[104:107], v10 offset:47104
  buffer_load_dwordx4 a[104:107], v4, s[4:7], s25 offen offset:2048 sc1
  s_waitcnt lgkmcnt(6)
  v_mfma_f32_32x32x16_bf16 v[44:59], v[112:115], a[108:111], v[44:59]
  ds_read_b128 v[108:111], v10 offset:35840
  s_waitcnt lgkmcnt(6)
  v_mfma_f32_32x32x16_bf16 v[60:75], v[116:119], a[108:111], v[60:75]
  ds_read_b128 v[112:115], v10 offset:39936
  s_waitcnt lgkmcnt(6)
  v_mfma_f32_32x32x16_bf16 v[76:91], v[120:123], a[108:111], v[76:91]
  ds_read_b128 v[116:119], v10 offset:44032
  s_waitcnt vmcnt(4)
  s_waitcnt lgkmcnt(6)
  v_mfma_f32_32x32x16_bf16 v[28:43], v[92:95], a[112:115], v[28:43]
  ds_read_b128 v[120:123], v10 offset:48128
  buffer_load_dwordx4 a[108:111], v4, s[4:7], s25 offen offset:3072 sc1
  s_waitcnt lgkmcnt(6)
  v_mfma_f32_32x32x16_bf16 v[44:59], v[96:99], a[112:115], v[44:59]
  ds_read_b128 v[92:95], v10 offset:49152
  s_waitcnt lgkmcnt(6)
  v_mfma_f32_32x32x16_bf16 v[60:75], v[100:103], a[112:115], v[60:75]
  ds_read_b128 v[96:99], v10 offset:53248
  s_waitcnt lgkmcnt(6)
  v_mfma_f32_32x32x16_bf16 v[76:91], v[104:107], a[112:115], v[76:91]
  ds_read_b128 v[100:103], v10 offset:57344
  s_waitcnt vmcnt(4)
  s_waitcnt lgkmcnt(6)
  v_mfma_f32_32x32x16_bf16 v[28:43], v[108:111], a[116:119], v[28:43]
  ds_read_b128 v[104:107], v10 offset:61440
  s_waitcnt lgkmcnt(6)
  v_mfma_f32_32x32x16_bf16 v[44:59], v[112:115], a[116:119], v[44:59]
  ds_read_b128 v[108:111], v10 offset:50176
  s_waitcnt lgkmcnt(6)
  v_mfma_f32_32x32x16_bf16 v[60:75], v[116:119], a[116:119], v[60:75]
  ds_read_b128 v[112:115], v10 offset:54272
  s_waitcnt lgkmcnt(6)
  v_mfma_f32_32x32x16_bf16 v[76:91], v[120:123], a[116:119], v[76:91]
  ds_read_b128 v[116:119], v10 offset:58368
  s_waitcnt vmcnt(3)
  s_waitcnt lgkmcnt(6)
  v_mfma_f32_32x32x16_bf16 v[28:43], v[92:95], a[120:123], v[28:43]
  ds_read_b128 v[120:123], v10 offset:62464
  s_waitcnt lgkmcnt(6)
  v_mfma_f32_32x32x16_bf16 v[44:59], v[96:99], a[120:123], v[44:59]
  ds_read_b128 v[92:95], v10 offset:51200
  s_waitcnt lgkmcnt(6)
  v_mfma_f32_32x32x16_bf16 v[60:75], v[100:103], a[120:123], v[60:75]
  ds_read_b128 v[96:99], v10 offset:55296
  s_waitcnt lgkmcnt(6)
  v_mfma_f32_32x32x16_bf16 v[76:91], v[104:107], a[120:123], v[76:91]
  ds_read_b128 v[100:103], v10 offset:59392
  s_waitcnt vmcnt(2)
  s_waitcnt lgkmcnt(6)
  v_mfma_f32_32x32x16_bf16 v[28:43], v[108:111], a[124:127], v[28:43]
  ds_read_b128 v[104:107], v10 offset:63488
  s_waitcnt lgkmcnt(6)
  v_mfma_f32_32x32x16_bf16 v[44:59], v[112:115], a[124:127], v[44:59]
  ds_read_b128 v[108:111], v10 offset:52224
  s_waitcnt lgkmcnt(6)
  v_mfma_f32_32x32x16_bf16 v[60:75], v[116:119], a[124:127], v[60:75]
  ds_read_b128 v[112:115], v10 offset:56320
  s_waitcnt lgkmcnt(6)
  v_mfma_f32_32x32x16_bf16 v[76:91], v[120:123], a[124:127], v[76:91]
  ds_read_b128 v[116:119], v10 offset:60416
  s_waitcnt vmcnt(1)
  s_waitcnt lgkmcnt(6)
  v_mfma_f32_32x32x16_bf16 v[28:43], v[92:95], a[104:107], v[28:43]
  ds_read_b128 v[120:123], v10 offset:64512
  s_waitcnt lgkmcnt(6)
  v_mfma_f32_32x32x16_bf16 v[44:59], v[96:99], a[104:107], v[44:59]
  s_waitcnt lgkmcnt(5)
  v_mfma_f32_32x32x16_bf16 v[60:75], v[100:103], a[104:107], v[60:75]
  s_waitcnt lgkmcnt(4)
  v_mfma_f32_32x32x16_bf16 v[76:91], v[104:107], a[104:107], v[76:91]
  s_waitcnt vmcnt(0)
  s_waitcnt lgkmcnt(3)
  v_mfma_f32_32x32x16_bf16 v[28:43], v[108:111], a[108:111], v[28:43]
  s_waitcnt lgkmcnt(2)
  v_mfma_f32_32x32x16_bf16 v[44:59], v[112:115], a[108:111], v[44:59]
  s_waitcnt lgkmcnt(1)
  v_mfma_f32_32x32x16_bf16 v[60:75], v[116:119], a[108:111], v[60:75]
  s_waitcnt lgkmcnt(0)
  v_mfma_f32_32x32x16_bf16 v[76:91], v[120:123], a[108:111], v[76:91]
  s_mul_i32 s34, s24, 112
  s_lshl_b32 s35, s23, 3
  s_add_u32 s34, s34, s35
  s_lshl_b32 s34, s34, 10
  s_add_u32 s34, s34, 0x1000000
  s_add_u32 s35, s34, 4096
  ds_read_b128 v[92:95], v19 offset:0
  ds_read_b128 v[96:99], v19 offset:32
  ds_read_b128 v[100:103], v19 offset:64
  ds_read_b128 v[104:107], v19 offset:96
  s_waitcnt lgkmcnt(0)
  s_nop 7
  s_nop 3
  v_pk_fma_f32 v[28:29], v[92:93], v[12:13], v[28:29] op_sel_hi:[1,0,1]
  v_pk_fma_f32 v[30:31], v[94:95], v[12:13], v[30:31] op_sel_hi:[1,0,1]
  v_pk_fma_f32 v[32:33], v[96:97], v[12:13], v[32:33] op_sel_hi:[1,0,1]
  v_pk_fma_f32 v[34:35], v[98:99], v[12:13], v[34:35] op_sel_hi:[1,0,1]
  v_pk_fma_f32 v[36:37], v[100:101], v[12:13], v[36:37] op_sel_hi:[1,0,1]
  v_pk_fma_f32 v[38:39], v[102:103], v[12:13], v[38:39] op_sel_hi:[1,0,1]
  v_pk_fma_f32 v[40:41], v[104:105], v[12:13], v[40:41] op_sel_hi:[1,0,1]
  v_pk_fma_f32 v[42:43], v[106:107], v[12:13], v[42:43] op_sel_hi:[1,0,1]
  v_pk_mul_f32 v[28:29], v[28:29], v[14:15] op_sel_hi:[1,0]
  v_pk_mul_f32 v[30:31], v[30:31], v[14:15] op_sel_hi:[1,0]
  v_pk_mul_f32 v[32:33], v[32:33], v[14:15] op_sel_hi:[1,0]
  v_pk_mul_f32 v[34:35], v[34:35], v[14:15] op_sel_hi:[1,0]
  v_pk_mul_f32 v[36:37], v[36:37], v[14:15] op_sel_hi:[1,0]
  v_pk_mul_f32 v[38:39], v[38:39], v[14:15] op_sel_hi:[1,0]
  v_pk_mul_f32 v[40:41], v[40:41], v[14:15] op_sel_hi:[1,0]
  v_pk_mul_f32 v[42:43], v[42:43], v[14:15] op_sel_hi:[1,0]
  v_cvt_pk_bf16_f32 v28, v28, v29
  v_cvt_pk_bf16_f32 v29, v30, v31
  v_cvt_pk_bf16_f32 v30, v32, v33
  v_cvt_pk_bf16_f32 v31, v34, v35
  v_cvt_pk_bf16_f32 v32, v36, v37
  v_cvt_pk_bf16_f32 v33, v38, v39
  v_cvt_pk_bf16_f32 v34, v40, v41
  v_cvt_pk_bf16_f32 v35, v42, v43
  v_pk_max_i16 v28, v28, 0
  v_pk_max_i16 v29, v29, 0
  v_pk_max_i16 v30, v30, 0
  v_pk_max_i16 v31, v31, 0
  v_pk_max_i16 v32, v32, 0
  v_pk_max_i16 v33, v33, 0
  v_pk_max_i16 v34, v34, 0
  v_pk_max_i16 v35, v35, 0
  buffer_store_dwordx4 v[28:31], v4, s[4:7], s34 offen offset:0
  buffer_store_dwordx4 v[32:35], v4, s[4:7], s34 offen offset:1024
  ds_read_b128 v[92:95], v19 offset:128
  ds_read_b128 v[96:99], v19 offset:160
  ds_read_b128 v[100:103], v19 offset:192
  ds_read_b128 v[104:107], v19 offset:224
  s_waitcnt lgkmcnt(0)
  v_pk_fma_f32 v[44:45], v[92:93], v[12:13], v[44:45] op_sel_hi:[1,0,1]
  v_pk_fma_f32 v[46:47], v[94:95], v[12:13], v[46:47] op_sel_hi:[1,0,1]
  v_pk_fma_f32 v[48:49], v[96:97], v[12:13], v[48:49] op_sel_hi:[1,0,1]
  v_pk_fma_f32 v[50:51], v[98:99], v[12:13], v[50:51] op_sel_hi:[1,0,1]
  v_pk_fma_f32 v[52:53], v[100:101], v[12:13], v[52:53] op_sel_hi:[1,0,1]
  v_pk_fma_f32 v[54:55], v[102:103], v[12:13], v[54:55] op_sel_hi:[1,0,1]
  v_pk_fma_f32 v[56:57], v[104:105], v[12:13], v[56:57] op_sel_hi:[1,0,1]
  v_pk_fma_f32 v[58:59], v[106:107], v[12:13], v[58:59] op_sel_hi:[1,0,1]
  v_pk_mul_f32 v[44:45], v[44:45], v[14:15] op_sel_hi:[1,0]
  v_pk_mul_f32 v[46:47], v[46:47], v[14:15] op_sel_hi:[1,0]
  v_pk_mul_f32 v[48:49], v[48:49], v[14:15] op_sel_hi:[1,0]
  v_pk_mul_f32 v[50:51], v[50:51], v[14:15] op_sel_hi:[1,0]
  v_pk_mul_f32 v[52:53], v[52:53], v[14:15] op_sel_hi:[1,0]
  v_pk_mul_f32 v[54:55], v[54:55], v[14:15] op_sel_hi:[1,0]
  v_pk_mul_f32 v[56:57], v[56:57], v[14:15] op_sel_hi:[1,0]
  v_pk_mul_f32 v[58:59], v[58:59], v[14:15] op_sel_hi:[1,0]
  v_cvt_pk_bf16_f32 v44, v44, v45
  v_cvt_pk_bf16_f32 v45, v46, v47
  v_cvt_pk_bf16_f32 v46, v48, v49
  v_cvt_pk_bf16_f32 v47, v50, v51
  v_cvt_pk_bf16_f32 v48, v52, v53
  v_cvt_pk_bf16_f32 v49, v54, v55
  v_cvt_pk_bf16_f32 v50, v56, v57
  v_cvt_pk_bf16_f32 v51, v58, v59
  v_pk_max_i16 v44, v44, 0
  v_pk_max_i16 v45, v45, 0
  v_pk_max_i16 v46, v46, 0
  v_pk_max_i16 v47, v47, 0
  v_pk_max_i16 v48, v48, 0
  v_pk_max_i16 v49, v49, 0
  v_pk_max_i16 v50, v50, 0
  v_pk_max_i16 v51, v51, 0
  buffer_store_dwordx4 v[44:47], v4, s[4:7], s34 offen offset:2048
  buffer_store_dwordx4 v[48:51], v4, s[4:7], s34 offen offset:3072
  ds_read_b128 v[92:95], v19 offset:256
  ds_read_b128 v[96:99], v19 offset:288
  ds_read_b128 v[100:103], v19 offset:320
  ds_read_b128 v[104:107], v19 offset:352
  s_waitcnt lgkmcnt(0)
  v_pk_fma_f32 v[60:61], v[92:93], v[12:13], v[60:61] op_sel_hi:[1,0,1]
  v_pk_fma_f32 v[62:63], v[94:95], v[12:13], v[62:63] op_sel_hi:[1,0,1]
  v_pk_fma_f32 v[64:65], v[96:97], v[12:13], v[64:65] op_sel_hi:[1,0,1]
  v_pk_fma_f32 v[66:67], v[98:99], v[12:13], v[66:67] op_sel_hi:[1,0,1]
  v_pk_fma_f32 v[68:69], v[100:101], v[12:13], v[68:69] op_sel_hi:[1,0,1]
  v_pk_fma_f32 v[70:71], v[102:103], v[12:13], v[70:71] op_sel_hi:[1,0,1]
  v_pk_fma_f32 v[72:73], v[104:105], v[12:13], v[72:73] op_sel_hi:[1,0,1]
  v_pk_fma_f32 v[74:75], v[106:107], v[12:13], v[74:75] op_sel_hi:[1,0,1]
  v_pk_mul_f32 v[60:61], v[60:61], v[14:15] op_sel_hi:[1,0]
  v_pk_mul_f32 v[62:63], v[62:63], v[14:15] op_sel_hi:[1,0]
  v_pk_mul_f32 v[64:65], v[64:65], v[14:15] op_sel_hi:[1,0]
  v_pk_mul_f32 v[66:67], v[66:67], v[14:15] op_sel_hi:[1,0]
  v_pk_mul_f32 v[68:69], v[68:69], v[14:15] op_sel_hi:[1,0]
  v_pk_mul_f32 v[70:71], v[70:71], v[14:15] op_sel_hi:[1,0]
  v_pk_mul_f32 v[72:73], v[72:73], v[14:15] op_sel_hi:[1,0]
  v_pk_mul_f32 v[74:75], v[74:75], v[14:15] op_sel_hi:[1,0]
  v_cvt_pk_bf16_f32 v60, v60, v61
  v_cvt_pk_bf16_f32 v61, v62, v63
  v_cvt_pk_bf16_f32 v62, v64, v65
  v_cvt_pk_bf16_f32 v63, v66, v67
  v_cvt_pk_bf16_f32 v64, v68, v69
  v_cvt_pk_bf16_f32 v65, v70, v71
  v_cvt_pk_bf16_f32 v66, v72, v73
  v_cvt_pk_bf16_f32 v67, v74, v75
  v_pk_max_i16 v60, v60, 0
  v_pk_max_i16 v61, v61, 0
  v_pk_max_i16 v62, v62, 0
  v_pk_max_i16 v63, v63, 0
  v_pk_max_i16 v64, v64, 0
  v_pk_max_i16 v65, v65, 0
  v_pk_max_i16 v66, v66, 0
  v_pk_max_i16 v67, v67, 0
  buffer_store_dwordx4 v[60:63], v4, s[4:7], s35 offen offset:0
  buffer_store_dwordx4 v[64:67], v4, s[4:7], s35 offen offset:1024
  ds_read_b128 v[92:95], v19 offset:384
  ds_read_b128 v[96:99], v19 offset:416
  ds_read_b128 v[100:103], v19 offset:448
  ds_read_b128 v[104:107], v19 offset:480
  s_waitcnt lgkmcnt(0)
  v_pk_fma_f32 v[76:77], v[92:93], v[12:13], v[76:77] op_sel_hi:[1,0,1]
  v_pk_fma_f32 v[78:79], v[94:95], v[12:13], v[78:79] op_sel_hi:[1,0,1]
  v_pk_fma_f32 v[80:81], v[96:97], v[12:13], v[80:81] op_sel_hi:[1,0,1]
  v_pk_fma_f32 v[82:83], v[98:99], v[12:13], v[82:83] op_sel_hi:[1,0,1]
  v_pk_fma_f32 v[84:85], v[100:101], v[12:13], v[84:85] op_sel_hi:[1,0,1]
  v_pk_fma_f32 v[86:87], v[102:103], v[12:13], v[86:87] op_sel_hi:[1,0,1]
  v_pk_fma_f32 v[88:89], v[104:105], v[12:13], v[88:89] op_sel_hi:[1,0,1]
  v_pk_fma_f32 v[90:91], v[106:107], v[12:13], v[90:91] op_sel_hi:[1,0,1]
  v_pk_mul_f32 v[76:77], v[76:77], v[14:15] op_sel_hi:[1,0]
  v_pk_mul_f32 v[78:79], v[78:79], v[14:15] op_sel_hi:[1,0]
  v_pk_mul_f32 v[80:81], v[80:81], v[14:15] op_sel_hi:[1,0]
  v_pk_mul_f32 v[82:83], v[82:83], v[14:15] op_sel_hi:[1,0]
  v_pk_mul_f32 v[84:85], v[84:85], v[14:15] op_sel_hi:[1,0]
  v_pk_mul_f32 v[86:87], v[86:87], v[14:15] op_sel_hi:[1,0]
  v_pk_mul_f32 v[88:89], v[88:89], v[14:15] op_sel_hi:[1,0]
  v_pk_mul_f32 v[90:91], v[90:91], v[14:15] op_sel_hi:[1,0]
  v_cvt_pk_bf16_f32 v76, v76, v77
  v_cvt_pk_bf16_f32 v77, v78, v79
  v_cvt_pk_bf16_f32 v78, v80, v81
  v_cvt_pk_bf16_f32 v79, v82, v83
  v_cvt_pk_bf16_f32 v80, v84, v85
  v_cvt_pk_bf16_f32 v81, v86, v87
  v_cvt_pk_bf16_f32 v82, v88, v89
  v_cvt_pk_bf16_f32 v83, v90, v91
  v_pk_max_i16 v76, v76, 0
  v_pk_max_i16 v77, v77, 0
  v_pk_max_i16 v78, v78, 0
  v_pk_max_i16 v79, v79, 0
  v_pk_max_i16 v80, v80, 0
  v_pk_max_i16 v81, v81, 0
  v_pk_max_i16 v82, v82, 0
  v_pk_max_i16 v83, v83, 0
  buffer_store_dwordx4 v[76:79], v4, s[4:7], s35 offen offset:2048
  buffer_store_dwordx4 v[80:83], v4, s[4:7], s35 offen offset:3072
  s_lshl_b32 s22, s12, 2
  s_lshr_b32 s26, s13, 3
  s_add_u32 s22, s22, s26
  s_and_b32 s23, s13, 7
  s_lshr_b32 s26, s3, 1
  s_and_b32 s26, s26, 1
  s_and_b32 s27, s3, 1
  s_lshl_b32 s28, s22, 1
  s_lshl_b32 s29, s23, 1
  s_add_u32 s30, s28, s26
  s_xor_b32 s26, s26, 1
  s_add_u32 s31, s28, s26
  s_add_u32 s33, s29, s27
  s_xor_b32 s27, s27, 1
  s_add_u32 s34, s29, s27
  s_lshl_b32 s40, s30, 5
  s_lshl_b32 s41, s33, 1
  s_add_u32 s40, s40, s41
  s_lshl_b32 s41, s40, 10
  s_mov_b32 s44, s41
  s_mov_b32 s42, 0x2000000
  s_lshl_b32 s43, s30, 12
  s_add_u32 s42, s42, s43
  s_lshl_b32 s43, s33, 3
  s_add_u32 s42, s42, s43
  s_mul_i32 s35, s3, 14
  s_mul_i32 s36, s30, 112
  s_add_u32 s36, s36, s35
  s_lshl_b32 s36, s36, 10
  s_add_u32 s36, s36, 0x1000000
  s_mul_i32 s37, s31, 112
  s_add_u32 s37, s37, s35
  s_lshl_b32 s37, s37, 10
  s_add_u32 s37, s37, 0x1000000
  s_mul_i32 s46, s33, 112
  s_add_u32 s46, s46, s35
  s_add_u32 s46, s46, 13
  s_lshl_b32 s46, s46, 10
  s_add_u32 s46, s46, 0x1d00000
  s_mul_i32 s47, s34, 112
  s_add_u32 s47, s47, s35
  s_add_u32 s47, s47, 13
  s_lshl_b32 s47, s47, 10
  s_add_u32 s47, s47, 0x1d00000
  s_waitcnt vmcnt(0)
  s_branch ffn1_done
ffn1_S:
  s_barrier
  s_and_b32 s46, s13, 15
  s_cmp_ge_u32 s46, 14
  s_cbranch_scc0 hw_33
  s_cmp_lg_u32 s14, 0
  s_cbranch_scc1 ip_34
  v_lshlrev_b32 v9, 7, v1
  s_lshr_b32 s46, s13, 4
  s_lshl_b32 s46, s46, 1
  s_and_b32 s47, s13, 1
  s_add_u32 s46, s46, s47
  s_lshl_b32 s46, s46, 3
  s_add_u32 s46, s46, s3
  s_mul_i32 s46, s46, 49152
  s_add_u32 s46, s46, 0x1800000
  buffer_load_dword v126, v9, s[4:7], s46 offen
  s_add_u32 s46, s46, 8192
  buffer_load_dword v126, v9, s[4:7], s46 offen
  s_add_u32 s46, s46, 8192
  buffer_load_dword v126, v9, s[4:7], s46 offen
  s_add_u32 s46, s46, 8192
  buffer_load_dword v126, v9, s[4:7], s46 offen
  s_add_u32 s46, s46, 8192
  buffer_load_dword v126, v9, s[4:7], s46 offen
  s_add_u32 s46, s46, 8192
  buffer_load_dword v126, v9, s[4:7], s46 offen
  s_add_u32 s46, s46, 8192
ip_34:
  s_branch hw_32_x
hw_33:
  s_lshr_b32 s22, s13, 4
  s_lshl_b32 s24, s12, 1
  s_add_u32 s22, s22, s24
  s_and_b32 s23, s13, 15
  s_cmp_eq_u32 s3, 4
  s_cbranch_scc0 cs_35
  s_lshl_b32 s40, s23, 2
  s_add_u32 s40, s40, 0
  s_lshl_b32 s41, s23, 2
  s_add_u32 s41, s41, 1
  s_lshl_b32 s42, s23, 2
  s_add_u32 s42, s42, 2
  s_lshl_b32 s43, s23, 2
  s_add_u32 s43, s43, 3
  v_mov_b32 v5, s40
  v_mov_b32 v6, s41
  v_cmp_eq_u32 vcc, 0, v3
  v_mov_b32 v7, s42
  v_mov_b32 v8, s43
  v_cndmask_b32 v5, v6, v5, vcc
  v_cndmask_b32 v6, v8, v7, vcc
  v_lshlrev_b32 v5, 7, v5
  v_lshlrev_b32 v6, 7, v6
  v_lshl_add_u32 v5, v2, 2, v5
  v_lshl_add_u32 v6, v2, 2, v6
  s_mov_b32 s33, 0x1f02000
  s_mov_b32 m0, 0x20000
  s_nop 0
  buffer_load_dword v5, s[4:7], s33 offen lds
  s_mov_b32 m0, 0x20100
  s_nop 0
  buffer_load_dword v6, s[4:7], s33 offen lds
cs_35:
  s_sub_u32 s30, s3, 4
  s_lshl_b32 s30, s30, 10
  s_lshl_b32 s26, s23, 2
  s_add_u32 s26, s26, 0
  s_lshl_b32 s26, s26, 15
  s_add_u32 s26, s26, s30
  s_add_u32 s26, s26, 0x1b00000
  s_lshl_b32 s27, s23, 2
  s_add_u32 s27, s27, 1
  s_lshl_b32 s27, s27, 15
  s_add_u32 s27, s27, s30
  s_add_u32 s27, s27, 0x1b00000
  s_lshl_b32 s28, s23, 2
  s_add_u32 s28, s28, 2
  s_lshl_b32 s28, s28, 15
  s_add_u32 s28, s28, s30
  s_add_u32 s28, s28, 0x1b00000
  s_lshl_b32 s29, s23, 2
  s_add_u32 s29, s29, 3
  s_lshl_b32 s29, s29, 15
  s_add_u32 s29, s29, s30
  s_add_u32 s29, s29, 0x1b00000
  s_add_u32 m0, s30, 0x14000
  s_add_u32 s34, s26, 0x5000
  buffer_load_dwordx4 v4, s[4:7], s34 offen lds
  s_add_u32 m0, s30, 0x15000
  s_add_u32 s34, s27, 0x5000
  buffer_load_dwordx4 v4, s[4:7], s34 offen lds
  s_add_u32 m0, s30, 0x16000
  s_add_u32 s34, s28, 0x5000
  buffer_load_dwordx4 v4, s[4:7], s34 offen lds
  s_add_u32 m0, s30, 0x17000
  s_add_u32 s34, s29, 0x5000
  buffer_load_dwordx4 v4, s[4:7], s34 offen lds
  s_add_u32 m0, s30, 0x18000
  s_add_u32 s34, s26, 0x6000
  buffer_load_dwordx4 v4, s[4:7], s34 offen lds
  s_add_u32 m0, s30, 0x19000
  s_add_u32 s34, s27, 0x6000
  buffer_load_dwordx4 v4, s[4:7], s34 offen lds
  s_add_u32 m0, s30, 0x1a000
  s_add_u32 s34, s28, 0x6000
  buffer_load_dwordx4 v4, s[4:7], s34 offen lds
  s_add_u32 m0, s30, 0x1b000
  s_add_u32 s34, s29, 0x6000
  buffer_load_dwordx4 v4, s[4:7], s34 offen lds
  s_add_u32 m0, s30, 0x1c000
  s_add_u32 s34, s26, 0x7000
  buffer_load_dwordx4 v4, s[4:7], s34 offen lds
  s_add_u32 m0, s30, 0x1d000
  s_add_u32 s34, s27, 0x7000
  buffer_load_dwordx4 v4, s[4:7], s34 offen lds
  s_add_u32 m0, s30, 0x1e000
  s_add_u32 s34, s28, 0x7000
  buffer_load_dwordx4 v4, s[4:7], s34 offen lds
  s_add_u32 m0, s30, 0x1f000
  s_add_u32 s34, s29, 0x7000
  buffer_load_dwordx4 v4, s[4:7], s34 offen lds
  s_waitcnt vmcnt(0)
hw_32_x:
  s_barrier
ffn1_Sfin:
  s_lshl_b32 s22, s12, 2
  s_lshr_b32 s26, s13, 3
  s_add_u32 s22, s22, s26
  s_and_b32 s23, s13, 7
  s_lshr_b32 s26, s3, 1
  s_and_b32 s26, s26, 1
  s_and_b32 s27, s3, 1
  s_lshl_b32 s28, s22, 1
  s_lshl_b32 s29, s23, 1
  s_add_u32 s30, s28, s26
  s_xor_b32 s26, s26, 1
  s_add_u32 s31, s28, s26
  s_add_u32 s33, s29, s27
  s_xor_b32 s27, s27, 1
  s_add_u32 s34, s29, s27
  s_lshl_b32 s40, s30, 5
  s_lshl_b32 s41, s33, 1
  s_add_u32 s40, s40, s41
  s_lshl_b32 s41, s40, 10
  s_mov_b32 s44, s41
  s_mov_b32 s42, 0x2000000
  s_lshl_b32 s43, s30, 12
  s_add_u32 s42, s42, s43
  s_lshl_b32 s43, s33, 3
  s_add_u32 s42, s42, s43
  s_mul_i32 s35, s3, 14
  s_mul_i32 s36, s30, 112
  s_add_u32 s36, s36, s35
  s_lshl_b32 s36, s36, 10
  s_add_u32 s36, s36, 0x1000000
  s_mul_i32 s37, s31, 112
  s_add_u32 s37, s37, s35
  s_lshl_b32 s37, s37, 10
  s_add_u32 s37, s37, 0x1000000
  s_mul_i32 s46, s33, 112
  s_add_u32 s46, s46, s35
  s_add_u32 s46, s46, 13
  s_lshl_b32 s46, s46, 10
  s_add_u32 s46, s46, 0x1d00000
  s_mul_i32 s47, s34, 112
  s_add_u32 s47, s47, s35
  s_add_u32 s47, s47, 13
  s_lshl_b32 s47, s47, 10
  s_add_u32 s47, s47, 0x1d00000
  s_branch ffn1_done
ffn1_idle:
  s_cmp_lg_u32 s14, 0
  s_cbranch_scc1 ip_36
  v_lshlrev_b32 v9, 7, v1
  s_lshr_b32 s46, s13, 4
  s_lshl_b32 s46, s46, 1
  s_and_b32 s47, s13, 1
  s_add_u32 s46, s46, s47
  s_lshl_b32 s46, s46, 3
  s_add_u32 s46, s46, s3
  s_mul_i32 s46, s46, 49152
  s_add_u32 s46, s46, 0x1800000
  buffer_load_dword v126, v9, s[4:7], s46 offen
  s_add_u32 s46, s46, 8192
  buffer_load_dword v126, v9, s[4:7], s46 offen
  s_add_u32 s46, s46, 8192
  buffer_load_dword v126, v9, s[4:7], s46 offen
  s_add_u32 s46, s46, 8192
  buffer_load_dword v126, v9, s[4:7], s46 offen
  s_add_u32 s46, s46, 8192
  buffer_load_dword v126, v9, s[4:7], s46 offen
  s_add_u32 s46, s46, 8192
  buffer_load_dword v126, v9, s[4:7], s46 offen
  s_add_u32 s46, s46, 8192
ip_36:
  s_barrier
  s_barrier
  s_lshl_b32 s22, s12, 2
  s_lshr_b32 s26, s13, 3
  s_add_u32 s22, s22, s26
  s_and_b32 s23, s13, 7
  s_lshr_b32 s26, s3, 1
  s_and_b32 s26, s26, 1
  s_and_b32 s27, s3, 1
  s_lshl_b32 s28, s22, 1
  s_lshl_b32 s29, s23, 1
  s_add_u32 s30, s28, s26
  s_xor_b32 s26, s26, 1
  s_add_u32 s31, s28, s26
  s_add_u32 s33, s29, s27
  s_xor_b32 s27, s27, 1
  s_add_u32 s34, s29, s27
  s_lshl_b32 s40, s30, 5
  s_lshl_b32 s41, s33, 1
  s_add_u32 s40, s40, s41
  s_lshl_b32 s41, s40, 10
  s_mov_b32 s44, s41
  s_mov_b32 s42, 0x2000000
  s_lshl_b32 s43, s30, 12
  s_add_u32 s42, s42, s43
  s_lshl_b32 s43, s33, 3
  s_add_u32 s42, s42, s43
  s_mul_i32 s35, s3, 14
  s_mul_i32 s36, s30, 112
  s_add_u32 s36, s36, s35
  s_lshl_b32 s36, s36, 10
  s_add_u32 s36, s36, 0x1000000
  s_mul_i32 s37, s31, 112
  s_add_u32 s37, s37, s35
  s_lshl_b32 s37, s37, 10
  s_add_u32 s37, s37, 0x1000000
  s_mul_i32 s46, s33, 112
  s_add_u32 s46, s46, s35
  s_add_u32 s46, s46, 13
  s_lshl_b32 s46, s46, 10
  s_add_u32 s46, s46, 0x1d00000
  s_mul_i32 s47, s34, 112
  s_add_u32 s47, s47, s35
  s_add_u32 s47, s47, 13
  s_lshl_b32 s47, s47, 10
  s_add_u32 s47, s47, 0x1d00000
ffn1_done:
  s_add_u32 s15, s15, 1
  s_lshl_b32 s86, s12, 7
  s_add_u32 s86, s86, 0x2200400
  s_lshl_b32 s87, s13, 2
  s_add_u32 s87, s87, s86
  v_mov_b32 v120, 0
  v_mov_b32 v121, s15
  v_lshlrev_b32 v122, 2, v1
  s_barrier
  s_cmp_eq_u32 s3, 0
  s_cbranch_scc0 lb3_37_not0
  s_mov_b64 exec, 1
  s_cmp_eq_u32 s18, 0
  s_cbranch_scc1 lb3_37_fast
  buffer_wbl2 sc1
  s_waitcnt vmcnt(0)
  buffer_store_dword v121, v120, s[4:7], s87 offen sc1
  s_branch lb3_37_sent
lb3_37_fast:
  buffer_store_dword v121, v120, s[4:7], s87 offen
lb3_37_sent:
  s_lshr_b32 s89, s13, 4
  s_lshl_b32 s89, s89, 6
  s_add_u32 s86, s86, s89
  s_mov_b32 exec_lo, 0xffff
  s_mov_b32 exec_hi, 0
  s_mov_b32 s88, 0
lb3_37_p1:
  buffer_load_dword v123, v122, s[4:7], s86 offen sc1
  s_waitcnt vmcnt(0)
  v_subrev_u32 v123, s15, v123
  v_cmp_le_u32 vcc, 64, v123
  s_add_u32 s88, s88, 1
  s_nop 1
  s_cmp_eq_u64 vcc, 0
  s_cbranch_scc1 lb3_37_p1_ok
  s_cmp_lt_u32 s88, 400000
  s_cbranch_scc1 lb3_37_p1
lb3_37_p1_ok:
  s_cmp_eq_u32 s18, 0
  s_cbranch_scc1 lb3_37_noinv
  buffer_inv sc1
  s_waitcnt vmcnt(0)
lb3_37_noinv:
  s_mov_b64 exec, -1
  s_branch lb3_37_join
lb3_37_not0:
lb3_37_join:
  s_barrier
  s_cmp_lt_u32 s3, 4
  s_cbranch_scc1 ffn2_lo
  s_setprio 1
ffn2_lo:
  buffer_load_dwordx4 v[80:83], v4, s[4:7], s36 offen offset:0 sc1
  buffer_load_dwordx4 v[84:87], v4, s[4:7], s37 offen offset:0 sc1
  buffer_load_dwordx4 v[112:115], v4, s[4:7], s46 offen
  buffer_load_dwordx4 v[116:119], v4, s[4:7], s47 offen
  buffer_load_dwordx4 v[8:11], v4, s[4:7], s41 offen sc1
  buffer_load_dwordx4 v[12:15], v4, s[4:7], s41 offen offset:1024 sc1
  buffer_load_dwordx4 v[88:91], v4, s[4:7], s36 offen offset:1024 sc1
  buffer_load_dwordx4 v[92:95], v4, s[4:7], s37 offen offset:1024 sc1
  buffer_load_dwordx4 v[96:99], v4, s[4:7], s36 offen offset:2048 sc1
  buffer_load_dwordx4 v[100:103], v4, s[4:7], s37 offen offset:2048 sc1
  buffer_load_dwordx4 v[104:107], v4, s[4:7], s36 offen offset:3072 sc1
  buffer_load_dwordx4 v[108:111], v4, s[4:7], s37 offen offset:3072 sc1
  s_add_u32 s36, s36, 4096
  s_add_u32 s37, s37, 4096
  s_waitcnt vmcnt(6)
  s_cmp_lt_u32 s3, 4
  s_cselect_b32 s45, -1, 0
  v_and_b32 v8, s45, v8
  v_and_b32 v9, s45, v9
  v_and_b32 v10, s45, v10
  v_and_b32 v11, s45, v11
  v_and_b32 v12, s45, v12
  v_and_b32 v13, s45, v13
  v_and_b32 v14, s45, v14
  v_and_b32 v15, s45, v15
  v_lshlrev_b32 v16, 16, v8
  v_and_b32 v17, 0xffff0000, v8
  v_lshlrev_b32 v18, 16, v9
  v_and_b32 v19, 0xffff0000, v9
  v_lshlrev_b32 v20, 16, v10
  v_and_b32 v21, 0xffff0000, v10
  v_lshlrev_b32 v22, 16, v11
  v_and_b32 v23, 0xffff0000, v11
  v_lshlrev_b32 v24, 16, v12
  v_and_b32 v25, 0xffff0000, v12
  v_lshlrev_b32 v26, 16, v13
  v_and_b32 v27, 0xffff0000, v13
  v_lshlrev_b32 v28, 16, v14
  v_and_b32 v29, 0xffff0000, v14
  v_lshlrev_b32 v30, 16, v15
  v_and_b32 v31, 0xffff0000, v15
  s_nop 1
  s_waitcnt vmcnt(10)
  v_mfma_f32_32x32x16_bf16 v[16:31], a[0:3], v[80:83], v[16:31]
  v_mfma_f32_32x32x16_bf16 v[32:47], a[4:7], v[80:83], 0
  v_mfma_f32_32x32x16_bf16 v[48:63], a[0:3], v[84:87], 0
  v_mfma_f32_32x32x16_bf16 v[64:79], a[4:7], v[84:87], 0
  buffer_load_dwordx4 v[80:83], v4, s[4:7], s36 offen offset:0 sc1
  buffer_load_dwordx4 v[84:87], v4, s[4:7], s37 offen offset:0 sc1
  s_waitcnt vmcnt(6)
  v_mfma_f32_32x32x16_bf16 v[16:31], a[8:11], v[88:91], v[16:31]
  v_mfma_f32_32x32x16_bf16 v[32:47], a[12:15], v[88:91], v[32:47]
  v_mfma_f32_32x32x16_bf16 v[48:63], a[8:11], v[92:95], v[48:63]
  v_mfma_f32_32x32x16_bf16 v[64:79], a[12:15], v[92:95], v[64:79]
  buffer_load_dwordx4 v[88:91], v4, s[4:7], s36 offen offset:1024 sc1
  buffer_load_dwordx4 v[92:95], v4, s[4:7], s37 offen offset:1024 sc1
  s_waitcnt vmcnt(6)
  v_mfma_f32_32x32x16_bf16 v[16:31], a[16:19], v[96:99], v[16:31]
  v_mfma_f32_32x32x16_bf16 v[32:47], a[20:23], v[96:99], v[32:47]
  v_mfma_f32_32x32x16_bf16 v[48:63], a[16:19], v[100:103], v[48:63]
  v_mfma_f32_32x32x16_bf16 v[64:79], a[20:23], v[100:103], v[64:79]
  buffer_load_dwordx4 v[96:99], v4, s[4:7], s36 offen offset:2048 sc1
  buffer_load_dwordx4 v[100:103], v4, s[4:7], s37 offen offset:2048 sc1
  s_waitcnt vmcnt(6)
  v_mfma_f32_32x32x16_bf16 v[16:31], a[24:27], v[104:107], v[16:31]
  v_mfma_f32_32x32x16_bf16 v[32:47], a[28:31], v[104:107], v[32:47]
  v_mfma_f32_32x32x16_bf16 v[48:63], a[24:27], v[108:111], v[48:63]
  v_mfma_f32_32x32x16_bf16 v[64:79], a[28:31], v[108:111], v[64:79]
  buffer_load_dwordx4 v[104:107], v4, s[4:7], s36 offen offset:3072 sc1
  buffer_load_dwordx4 v[108:111], v4, s[4:7], s37 offen offset:3072 sc1
  s_add_u32 s36, s36, 4096
  s_add_u32 s37, s37, 4096
  s_waitcnt vmcnt(6)
  v_mfma_f32_32x32x16_bf16 v[16:31], a[32:35], v[80:83], v[16:31]
  v_mfma_f32_32x32x16_bf16 v[32:47], a[36:39], v[80:83], v[32:47]
  v_mfma_f32_32x32x16_bf16 v[48:63], a[32:35], v[84:87], v[48:63]
  v_mfma_f32_32x32x16_bf16 v[64:79], a[36:39], v[84:87], v[64:79]
  buffer_load_dwordx4 v[80:83], v4, s[4:7], s36 offen offset:0 sc1
  buffer_load_dwordx4 v[84:87], v4, s[4:7], s37 offen offset:0 sc1
  s_waitcnt vmcnt(6)
  v_mfma_f32_32x32x16_bf16 v[16:31], a[40:43], v[88:91], v[16:31]
  v_mfma_f32_32x32x16_bf16 v[32:47], a[44:47], v[88:91], v[32:47]
  v_mfma_f32_32x32x16_bf16 v[48:63], a[40:43], v[92:95], v[48:63]
  v_mfma_f32_32x32x16_bf16 v[64:79], a[44:47], v[92:95], v[64:79]
  buffer_load_dwordx4 v[88:91], v4, s[4:7], s36 offen offset:1024 sc1
  buffer_load_dwordx4 v[92:95], v4, s[4:7], s37 offen offset:1024 sc1
  s_waitcnt vmcnt(6)
  v_mfma_f32_32x32x16_bf16 v[16:31], a[48:51], v[96:99], v[16:31]
  v_mfma_f32_32x32x16_bf16 v[32:47], a[52:55], v[96:99], v[32:47]
  v_mfma_f32_32x32x16_bf16 v[48:63], a[48:51], v[100:103], v[48:63]
  v_mfma_f32_32x32x16_bf16 v[64:79], a[52:55], v[100:103], v[64:79]
  buffer_load_dwordx4 v[96:99], v4, s[4:7], s36 offen offset:2048 sc1
  buffer_load_dwordx4 v[100:103], v4, s[4:7], s37 offen offset:2048 sc1
  s_waitcnt vmcnt(6)
  v_mfma_f32_32x32x16_bf16 v[16:31], a[56:59], v[104:107], v[16:31]
  v_mfma_f32_32x32x16_bf16 v[32:47], a[60:63], v[104:107], v[32:47]
  v_mfma_f32_32x32x16_bf16 v[48:63], a[56:59], v[108:111], v[48:63]
  v_mfma_f32_32x32x16_bf16 v[64:79], a[60:63], v[108:111], v[64:79]
  buffer_load_dwordx4 v[104:107], v4, s[4:7], s36 offen offset:3072 sc1
  buffer_load_dwordx4 v[108:111], v4, s[4:7], s37 offen offset:3072 sc1
  s_add_u32 s36, s36, 4096
  s_add_u32 s37, s37, 4096
  s_waitcnt vmcnt(6)
  v_mfma_f32_32x32x16_bf16 v[16:31], a[64:67], v[80:83], v[16:31]
  v_mfma_f32_32x32x16_bf16 v[32:47], a[68:71], v[80:83], v[32:47]
  v_mfma_f32_32x32x16_bf16 v[48:63], a[64:67], v[84:87], v[48:63]
  v_mfma_f32_32x32x16_bf16 v[64:79], a[68:71], v[84:87], v[64:79]
  buffer_load_dwordx4 v[80:83], v4, s[4:7], s36 offen offset:0 sc1
  buffer_load_dwordx4 v[84:87], v4, s[4:7], s37 offen offset:0 sc1
  s_waitcnt vmcnt(6)
  v_mfma_f32_32x32x16_bf16 v[16:31], a[72:75], v[88:91], v[16:31]
  v_mfma_f32_32x32x16_bf16 v[32:47], a[76:79], v[88:91], v[32:47]
  v_mfma_f32_32x32x16_bf16 v[48:63], a[72:75], v[92:95], v[48:63]
  v_mfma_f32_32x32x16_bf16 v[64:79], a[76:79], v[92:95], v[64:79]
  buffer_load_dwordx4 v[88:91], v4, s[4:7], s36 offen offset:1024 sc1
  buffer_load_dwordx4 v[92:95], v4, s[4:7], s37 offen offset:1024 sc1
  s_waitcnt vmcnt(6)
  v_mfma_f32_32x32x16_bf16 v[16:31], a[80:83], v[96:99], v[16:31]
  v_mfma_f32_32x32x16_bf16 v[32:47], a[84:87], v[96:99], v[32:47]
  v_mfma_f32_32x32x16_bf16 v[48:63], a[80:83], v[100:103], v[48:63]
  v_mfma_f32_32x32x16_bf16 v[64:79], a[84:87], v[100:103], v[64:79]
  s_waitcnt vmcnt(4)
  v_mfma_f32_32x32x16_bf16 v[16:31], a[88:91], v[104:107], v[16:31]
  v_mfma_f32_32x32x16_bf16 v[32:47], a[92:95], v[104:107], v[32:47]
  v_mfma_f32_32x32x16_bf16 v[48:63], a[88:91], v[108:111], v[48:63]
  v_mfma_f32_32x32x16_bf16 v[64:79], a[92:95], v[108:111], v[64:79]
  s_waitcnt vmcnt(2)
  v_mfma_f32_32x32x16_bf16 v[16:31], a[96:99], v[80:83], v[16:31]
  v_mfma_f32_32x32x16_bf16 v[32:47], a[100:103], v[80:83], v[32:47]
  v_mfma_f32_32x32x16_bf16 v[48:63], a[96:99], v[84:87], v[48:63]
  v_mfma_f32_32x32x16_bf16 v[64:79], a[100:103], v[84:87], v[64:79]
  s_waitcnt vmcnt(0)
  v_mfma_f32_32x32x16_bf16 v[16:31], v[112:115], v[88:91], v[16:31]
  v_mfma_f32_32x32x16_bf16 v[32:47], v[116:119], v[88:91], v[32:47]
  v_mfma_f32_32x32x16_bf16 v[48:63], v[112:115], v[92:95], v[48:63]
  v_mfma_f32_32x32x16_bf16 v[64:79], v[116:119], v[92:95], v[64:79]
  s_nop 15
  s_nop 3
  s_and_b32 s46, s3, 3
  s_cmp_ge_u32 s3, 4
  s_cbranch_scc1 ffn2_hi
  s_xor_b32 s45, s46, 1
  s_mul_i32 s45, s45, 28672
  s_add_u32 s45, s45, 49152
  v_add_u32 v5, s45, v4
  ds_write_b128 v5, v[32:35] offset:0
  ds_write_b128 v5, v[36:39] offset:1024
  ds_write_b128 v5, v[40:43] offset:2048
  ds_write_b128 v5, v[44:47] offset:3072
  s_xor_b32 s45, s46, 2
  s_mul_i32 s45, s45, 28672
  s_add_u32 s45, s45, 53248
  v_add_u32 v5, s45, v4
  ds_write_b128 v5, v[48:51] offset:0
  ds_write_b128 v5, v[52:55] offset:1024
  ds_write_b128 v5, v[56:59] offset:2048
  ds_write_b128 v5, v[60:63] offset:3072
  s_xor_b32 s45, s46, 3
  s_mul_i32 s45, s45, 28672
  s_add_u32 s45, s45, 57344
  v_add_u32 v5, s45, v4
  ds_write_b128 v5, v[64:67] offset:0
  ds_write_b128 v5, v[68:71] offset:1024
  ds_write_b128 v5, v[72:75] offset:2048
  ds_write_b128 v5, v[76:79] offset:3072
  s_mul_i32 s45, s3, 28672
  s_add_u32 s45, s45, 49152
  v_add_u32 v5, s45, v4
  s_waitcnt lgkmcnt(0)
  s_barrier
  ds_read_b128 v[32:35], v5 offset:0
  ds_read_b128 v[36:39], v5 offset:1024
  ds_read_b128 v[40:43], v5 offset:2048
  ds_read_b128 v[44:47], v5 offset:3072
  ds_read_b128 v[48:51], v5 offset:4096
  ds_read_b128 v[52:55], v5 offset:5120
  ds_read_b128 v[56:59], v5 offset:6144
  ds_read_b128 v[60:63], v5 offset:7168
  ds_read_b128 v[64:67], v5 offset:8192
  ds_read_b128 v[68:71], v5 offset:9216
  ds_read_b128 v[72:75], v5 offset:10240
  ds_read_b128 v[76:79], v5 offset:11264
  ds_read_b128 v[80:83], v5 offset:12288
  ds_read_b128 v[84:87], v5 offset:13312
  ds_read_b128 v[88:91], v5 offset:14336
  ds_read_b128 v[92:95], v5 offset:15360
  ds_read_b128 v[96:99], v5 offset:16384
  ds_read_b128 v[100:103], v5 offset:17408
  ds_read_b128 v[104:107], v5 offset:18432
  ds_read_b128 v[108:111], v5 offset:19456
  s_waitcnt lgkmcnt(15)
  v_pk_add_f32 v[16:17], v[16:17], v[32:33]
  v_pk_add_f32 v[18:19], v[18:19], v[34:35]
  v_pk_add_f32 v[20:21], v[20:21], v[36:37]
  v_pk_add_f32 v[22:23], v[22:23], v[38:39]
  v_pk_add_f32 v[24:25], v[24:25], v[40:41]
  v_pk_add_f32 v[26:27], v[26:27], v[42:43]
  v_pk_add_f32 v[28:29], v[28:29], v[44:45]
  v_pk_add_f32 v[30:31], v[30:31], v[46:47]
  s_waitcnt lgkmcnt(12)
  v_pk_add_f32 v[16:17], v[16:17], v[48:49]
  v_pk_add_f32 v[18:19], v[18:19], v[50:51]
  v_pk_add_f32 v[20:21], v[20:21], v[52:53]
  v_pk_add_f32 v[22:23], v[22:23], v[54:55]
  v_pk_add_f32 v[24:25], v[24:25], v[56:57]
  v_pk_add_f32 v[26:27], v[26:27], v[58:59]
  v_pk_add_f32 v[28:29], v[28:29], v[60:61]
  v_pk_add_f32 v[30:31], v[30:31], v[62:63]
  s_waitcnt lgkmcnt(8)
  v_pk_add_f32 v[16:17], v[16:17], v[64:65]
  v_pk_add_f32 v[18:19], v[18:19], v[66:67]
  v_pk_add_f32 v[20:21], v[20:21], v[68:69]
  v_pk_add_f32 v[22:23], v[22:23], v[70:71]
  v_pk_add_f32 v[24:25], v[24:25], v[72:73]
  v_pk_add_f32 v[26:27], v[26:27], v[74:75]
  v_pk_add_f32 v[28:29], v[28:29], v[76:77]
  v_pk_add_f32 v[30:31], v[30:31], v[78:79]
  ds_read_b128 v[32:35], v5 offset:20480
  ds_read_b128 v[36:39], v5 offset:21504
  ds_read_b128 v[40:43], v5 offset:22528
  ds_read_b128 v[44:47], v5 offset:23552
  ds_read_b128 v[48:51], v5 offset:24576
  ds_read_b128 v[52:55], v5 offset:25600
  ds_read_b128 v[56:59], v5 offset:26624
  ds_read_b128 v[60:63], v5 offset:27648
  s_waitcnt lgkmcnt(12)
  v_pk_add_f32 v[16:17], v[16:17], v[80:81]
  v_pk_add_f32 v[18:19], v[18:19], v[82:83]
  v_pk_add_f32 v[20:21], v[20:21], v[84:85]
  v_pk_add_f32 v[22:23], v[22:23], v[86:87]
  v_pk_add_f32 v[24:25], v[24:25], v[88:89]
  v_pk_add_f32 v[26:27], v[26:27], v[90:91]
  v_pk_add_f32 v[28:29], v[28:29], v[92:93]
  v_pk_add_f32 v[30:31], v[30:31], v[94:95]
  s_waitcnt lgkmcnt(8)
  v_pk_add_f32 v[16:17], v[16:17], v[96:97]
  v_pk_add_f32 v[18:19], v[18:19], v[98:99]
  v_pk_add_f32 v[20:21], v[20:21], v[100:101]
  v_pk_add_f32 v[22:23], v[22:23], v[102:103]
  v_pk_add_f32 v[24:25], v[24:25], v[104:105]
  v_pk_add_f32 v[26:27], v[26:27], v[106:107]
  v_pk_add_f32 v[28:29], v[28:29], v[108:109]
  v_pk_add_f32 v[30:31], v[30:31], v[110:111]
  s_waitcnt lgkmcnt(4)
  v_pk_add_f32 v[16:17], v[16:17], v[32:33]
  v_pk_add_f32 v[18:19], v[18:19], v[34:35]
  v_pk_add_f32 v[20:21], v[20:21], v[36:37]
  v_pk_add_f32 v[22:23], v[22:23], v[38:39]
  v_pk_add_f32 v[24:25], v[24:25], v[40:41]
  v_pk_add_f32 v[26:27], v[26:27], v[42:43]
  v_pk_add_f32 v[28:29], v[28:29], v[44:45]
  v_pk_add_f32 v[30:31], v[30:31], v[46:47]
  s_waitcnt lgkmcnt(0)
  v_pk_add_f32 v[16:17], v[16:17], v[48:49]
  v_pk_add_f32 v[18:19], v[18:19], v[50:51]
  v_pk_add_f32 v[20:21], v[20:21], v[52:53]
  v_pk_add_f32 v[22:23], v[22:23], v[54:55]
  v_pk_add_f32 v[24:25], v[24:25], v[56:57]
  v_pk_add_f32 v[26:27], v[26:27], v[58:59]
  v_pk_add_f32 v[28:29], v[28:29], v[60:61]
  v_pk_add_f32 v[30:31], v[30:31], v[62:63]
  v_cvt_pk_bf16_f32 v8, v16, v17
  v_cvt_pk_bf16_f32 v9, v18, v19
  v_cvt_pk_bf16_f32 v10, v20, v21
  v_cvt_pk_bf16_f32 v11, v22, v23
  v_cvt_pk_bf16_f32 v12, v24, v25
  v_cvt_pk_bf16_f32 v13, v26, v27
  v_cvt_pk_bf16_f32 v14, v28, v29
  v_cvt_pk_bf16_f32 v15, v30, v31
  s_cmp_lg_u32 s14, 0
  s_cbranch_scc1 ffn2_final
  buffer_store_dwordx4 v[8:11], v4, s[4:7], s44 offen
  buffer_store_dwordx4 v[12:15], v4, s[4:7], s44 offen offset:1024
  v_mov_b32 v16, 0
  v_mov_b32 v17, 0
  v_mov_b32 v5, 0x3f803f80
  v_dot2c_f32_bf16 v16, v8, v5
  v_dot2c_f32_bf16 v17, v8, v8
  v_dot2c_f32_bf16 v16, v9, v5
  v_dot2c_f32_bf16 v17, v9, v9
  v_dot2c_f32_bf16 v16, v10, v5
  v_dot2c_f32_bf16 v17, v10, v10
  v_dot2c_f32_bf16 v16, v11, v5
  v_dot2c_f32_bf16 v17, v11, v11
  v_dot2c_f32_bf16 v16, v12, v5
  v_dot2c_f32_bf16 v17, v12, v12
  v_dot2c_f32_bf16 v16, v13, v5
  v_dot2c_f32_bf16 v17, v13, v13
  v_dot2c_f32_bf16 v16, v14, v5
  v_dot2c_f32_bf16 v17, v14, v14
  v_dot2c_f32_bf16 v16, v15, v5
  v_dot2c_f32_bf16 v17, v15, v15
  s_nop 4
  v_mov_b32 v5, v16
  s_nop 1
  v_permlane32_swap_b32 v16, v5
  s_nop 1
  v_add_f32 v16, v16, v5
  v_mov_b32 v5, v17
  s_nop 1
  v_permlane32_swap_b32 v17, v5
  s_nop 1
  v_add_f32 v17, v17, v5
  v_lshlrev_b32 v5, 7, v2
  s_nop 0
  buffer_store_dwordx2 v[16:17], v5, s[4:7], s42 offen
  s_lshr_b32 s22, s13, 4
  s_lshl_b32 s24, s12, 1
  s_add_u32 s22, s22, s24
  s_and_b32 s23, s13, 15
  s_and_b32 s24, s3, 3
  s_lshl_b32 s25, s22, 2
  s_add_u32 s24, s24, s25
  s_lshl_b32 s25, s24, 15
  v_lshlrev_b32 v7, 7, v2
  v_lshl_add_u32 v7, v3, 6, v7
  s_lshl_b32 s31, s24, 12
  s_add_u32 s31, s31, 0x2000000
  v_mov_b32 v9, v4
  v_add_u32 v10, 0x10000, v4
  s_waitcnt vmcnt(0)
  s_branch ffn2_done
ffn2_final:
  v_lshlrev_b32 v5, 10, v2
  v_lshl_add_u32 v5, v3, 4, v5
  s_lshl_b32 s42, s30, 15
  s_lshl_b32 s43, s33, 6
  s_add_u32 s42, s42, s43
  v_permlane32_swap_b32 v8, v10
  v_permlane32_swap_b32 v9, v11
  v_permlane32_swap_b32 v12, v14
  v_permlane32_swap_b32 v13, v15
  s_nop 1
  buffer_store_dwordx4 v[8:11], v5, s[8:11], s42 offen offset:0
  buffer_store_dwordx4 v[12:15], v5, s[8:11], s42 offen offset:32
  s_branch ffn2_done
ffn2_hi:
  s_setprio 0
  s_xor_b32 s45, s46, 0
  s_mul_i32 s45, s45, 28672
  s_add_u32 s45, s45, 61440
  v_add_u32 v5, s45, v4
  ds_write_b128 v5, v[16:19] offset:0
  ds_write_b128 v5, v[20:23] offset:1024
  ds_write_b128 v5, v[24:27] offset:2048
  ds_write_b128 v5, v[28:31] offset:3072
  s_xor_b32 s45, s46, 1
  s_mul_i32 s45, s45, 28672
  s_add_u32 s45, s45, 65536
  v_add_u32 v5, s45, v4
  ds_write_b128 v5, v[32:35] offset:0
  ds_write_b128 v5, v[36:39] offset:1024
  ds_write_b128 v5, v[40:43] offset:2048
  ds_write_b128 v5, v[44:47] offset:3072
  s_xor_b32 s45, s46, 2
  s_mul_i32 s45, s45, 28672
  s_add_u32 s45, s45, 69632
  v_add_u32 v5, s45, v4
  ds_write_b128 v5, v[48:51] offset:0
  ds_write_b128 v5, v[52:55] offset:1024
  ds_write_b128 v5, v[56:59] offset:2048
  ds_write_b128 v5, v[60:63] offset:3072
  s_xor_b32 s45, s46, 3
  s_mul_i32 s45, s45, 28672
  s_add_u32 s45, s45, 73728
  v_add_u32 v5, s45, v4
  ds_write_b128 v5, v[64:67] offset:0
  ds_write_b128 v5, v[68:71] offset:1024
  ds_write_b128 v5, v[72:75] offset:2048
  ds_write_b128 v5, v[76:79] offset:3072
  s_waitcnt lgkmcnt(0)
  s_barrier
  s_cmp_lg_u32 s14, 0
  s_cbranch_scc1 hw_38
  s_lshr_b32 s22, s13, 4
  s_lshl_b32 s24, s12, 1
  s_add_u32 s22, s22, s24
  s_and_b32 s23, s13, 15
  s_lshl_b32 s49, s23, 7
  s_lshl_b32 s46, s22, 2
  s_add_u32 s49, s49, s46
  s_lshl_b32 s49, s49, 10
  s_add_u32 s49, s49, 0x800000
  s_cmp_eq_u32 s3, 6
  s_cbranch_scc0 t_39
  v_lshlrev_b32 v9, 7, v2
  s_mov_b32 s47, 65536
  v_mad_u32_u24 v9, v3, s47, v9
  buffer_load_dword v126, v9, s[4:7], s49 offen
t_39:
  s_sub_u32 s30, s3, 4
  s_lshl_b32 s30, s30, 10
  s_add_u32 s26, s23, 0
  s_lshl_b32 s26, s26, 15
  s_add_u32 s26, s26, s30
  s_add_u32 s26, s26, 0x1800000
  s_add_u32 s27, s23, 16
  s_lshl_b32 s27, s27, 15
  s_add_u32 s27, s27, s30
  s_add_u32 s27, s27, 0x1800000
  s_add_u32 s28, s23, 32
  s_lshl_b32 s28, s28, 15
  s_add_u32 s28, s28, s30
  s_add_u32 s28, s28, 0x1800000
  s_cmp_eq_u32 s3, 4
  s_cbranch_scc0 cs_40
cs_40:
  s_add_u32 m0, s30, 0x0
  s_add_u32 s34, s26, 0x0
  buffer_load_dwordx4 v4, s[4:7], s34 offen lds
  s_add_u32 m0, s30, 0x1000
  s_add_u32 s34, s27, 0x0
  buffer_load_dwordx4 v4, s[4:7], s34 offen lds
  s_add_u32 m0, s30, 0x2000
  s_add_u32 s34, s28, 0x0
  buffer_load_dwordx4 v4, s[4:7], s34 offen lds
  s_add_u32 m0, s30, 0x3000
  s_add_u32 s34, s26, 0x1000
  buffer_load_dwordx4 v4, s[4:7], s34 offen lds
  s_add_u32 m0, s30, 0x4000
  s_add_u32 s34, s27, 0x1000
  buffer_load_dwordx4 v4, s[4:7], s34 offen lds
  s_add_u32 m0, s30, 0x5000
  s_add_u32 s34, s28, 0x1000
  buffer_load_dwordx4 v4, s[4:7], s34 offen lds
  s_add_u32 m0, s30, 0x6000
  s_add_u32 s34, s26, 0x2000
  buffer_load_dwordx4 v4, s[4:7], s34 offen lds
  s_add_u32 m0, s30, 0x7000
  s_add_u32 s34, s27, 0x2000
  buffer_load_dwordx4 v4, s[4:7], s34 offen lds
  s_add_u32 m0, s30, 0x8000
  s_add_u32 s34, s28, 0x2000
  buffer_load_dwordx4 v4, s[4:7], s34 offen lds
  s_add_u32 m0, s30, 0x9000
  s_add_u32 s34, s26, 0x3000
  buffer_load_dwordx4 v4, s[4:7], s34 offen lds
  s_add_u32 m0, s30, 0xa000
  s_add_u32 s34, s27, 0x3000
  buffer_load_dwordx4 v4, s[4:7], s34 offen lds
  s_add_u32 m0, s30, 0xb000
  s_add_u32 s34, s28, 0x3000
  buffer_load_dwordx4 v4, s[4:7], s34 offen lds
hw_38:
ffn2_done:
  s_cmp_lg_u32 s14, 0
  s_cbranch_scc1 main_fin
  s_add_u32 s15, s15, 1
  s_lshl_b32 s86, s12, 7
  s_add_u32 s86, s86, 0x2200400
  s_lshl_b32 s87, s13, 2
  s_add_u32 s87, s87, s86
  v_mov_b32 v120, 0
  v_mov_b32 v121, s15
  v_lshlrev_b32 v122, 2, v1
  s_barrier
  s_cmp_eq_u32 s3, 0
  s_cbranch_scc0 lb4_41_not0
  s_mov_b64 exec, 1
  s_cmp_eq_u32 s18, 0
  s_cbranch_scc1 lb4_41_fast
  buffer_wbl2 sc1
  s_waitcnt vmcnt(0)
  buffer_store_dword v121, v120, s[4:7], s87 offen sc1
  s_branch lb4_41_sent
lb4_41_fast:
  buffer_store_dword v121, v120, s[4:7], s87 offen
lb4_41_sent:
  s_lshr_b32 s89, s13, 4
  s_lshl_b32 s89, s89, 6
  s_add_u32 s86, s86, s89
  s_mov_b32 exec_lo, 0xffff
  s_mov_b32 exec_hi, 0
  s_mov_b32 s88, 0
lb4_41_p1:
  buffer_load_dword v123, v122, s[4:7], s86 offen sc1
  s_waitcnt vmcnt(0)
  v_subrev_u32 v123, s15, v123
  v_cmp_le_u32 vcc, 64, v123
  s_add_u32 s88, s88, 1
  s_nop 1
  s_cmp_eq_u64 vcc, 0
  s_cbranch_scc1 lb4_41_p1_ok
  s_cmp_lt_u32 s88, 400000
  s_cbranch_scc1 lb4_41_p1
lb4_41_p1_ok:
  s_cmp_eq_u32 s18, 0
  s_cbranch_scc1 lb4_41_noinv
  buffer_inv sc1
  s_waitcnt vmcnt(0)
lb4_41_noinv:
  s_mov_b64 exec, -1
  s_branch lb4_41_join
lb4_41_not0:
lb4_41_join:
  s_barrier
  s_mov_b32 s14, 1
  s_mov_b32 s19, 0x1c00000
  s_branch L_qkv
main_fin:
main_end:
  s_endpgm
.section .rodata,"a"
.p2align 6
.p2align 6
.amdhsa_kernel prep_kernel
  .amdhsa_next_free_vgpr 128
  .amdhsa_next_free_sgpr 96
  .amdhsa_accum_offset 128
  .amdhsa_group_segment_fixed_size 0
  .amdhsa_kernarg_size 72
  .amdhsa_user_sgpr_count 2
  .amdhsa_user_sgpr_kernarg_segment_ptr 1
  .amdhsa_system_sgpr_workgroup_id_x 1
.end_amdhsa_kernel
.p2align 6
.amdhsa_kernel main_kernel
  .amdhsa_next_free_vgpr 256
  .amdhsa_next_free_sgpr 96
  .amdhsa_accum_offset 128
  .amdhsa_group_segment_fixed_size 0
  .amdhsa_kernarg_size 72
  .amdhsa_user_sgpr_count 2
  .amdhsa_user_sgpr_kernarg_segment_ptr 1
  .amdhsa_system_sgpr_workgroup_id_x 1
.end_amdhsa_kernel
```
